```python
import torch

def _softmax(x, axis=-1):
    return torch.softmax(x, dim=axis)

def _gelu(x):
    return torch.nn.functional.gelu(x, approximate='tanh')

def _silu(x):
    return torch.nn.functional.silu(x)

def _sigmoid(x):
    return torch.sigmoid(x)

def _layernorm(x, axis=-1, eps=1e-05):
    m = x.mean(dim=axis, keepdim=True)
    v = x.var(dim=axis, keepdim=True, unbiased=False)
    return (x - m) / torch.sqrt(v + eps)

def _scatter_add(tgt, idx, src, axis=0):
    return tgt.clone().index_add_(axis, idx, src)

def _segment_sum(src, seg, n):
    out = torch.zeros((n,) + src.shape[1:], dtype=src.dtype)
    return out.index_add_(0, seg, src)

def _pad(x, pw):
    flat = tuple((v for pair in reversed(pw) for v in pair))
    return torch.nn.functional.pad(x, flat)
kernel_name = 'standalone__dilated_atrous__vision'

def setup_inputs():

    _w = lambda a: (lambda t: t.to(torch.bfloat16) if t.is_floating_point() else t)(torch.as_tensor(a))
    H = W = 224
    C = 96
    k = 3
    return {'x': _w((lambda *s: torch.randn(*s, dtype=torch.bfloat16) * 0.05)(1, H, W, C)), 'w': _w((lambda *s: torch.randn(*s, dtype=torch.bfloat16) * 0.05)(k, k, C, C) * (1.0 / (k * C ** 0.5)))}

def reference(x, w):
    B, H, W, C = x.shape
    k = 3
    rate = 2
    pad = (k - 1) * rate // 2
    xp = _pad(x, ((0, 0), (pad, pad), (pad, pad), (0, 0)))
    out = torch.zeros_like(x)
    for i in range(k):
        for j in range(k):
            tap = xp[:, i * rate:i * rate + H, j * rate:j * rate + W, :].clone()
            out = out + torch.einsum('bhwc,co->bhwo', tap, w[i, j])
    return out
```

```asm
; @launch grid=(224,1,1) block=(256,1,1) lds=163328
.amdgcn_target "amdgcn-amd-amdhsa--gfx950"
.text
.globl standalone__dilated_atrous__vision_kernel
.p2align 8
.type standalone__dilated_atrous__vision_kernel,@function
standalone__dilated_atrous__vision_kernel:
    s_cmp_ge_u32 s2, 224
    s_cbranch_scc1 L_done
    s_load_dwordx4 s[4:7], s[0:1], 0
    s_load_dwordx2 s[34:35], s[0:1], 16
    v_and_b32 v1, 63, v0
    v_lshrrev_b32 v14, 6, v0
    s_nop 0
    v_readfirstlane_b32 s20, v14
    s_and_b32 s27, s2, 7
    s_lshr_b32 s26, s2, 3
    s_cmp_ge_u32 s26, 14
    s_cselect_b32 s25, 1, 0
    s_cselect_b32 s24, 14, 0
    s_sub_u32 s23, s26, s24
    s_lshl_b32 s27, s27, 1
    s_add_u32 s25, s25, s27
    s_mul_i32 s21, s25, 14
    s_lshl_b32 s22, s23, 4
    s_mov_b32 s32, 1073741824
    s_cmp_eq_u32 s23, 0
    s_cselect_b32 s33, 384, 0
    v_mul_u32_u24 v14, 4682, v1
    v_lshrrev_b32 v14, 16, v14
    v_mul_u32_u24 v15, 14, v14
    v_sub_u32 v15, v1, v15
    v_mul_u32_u24 v16, 192, v14
    v_lshl_add_u32 v2, v15, 4, v16
    v_mov_b32 v17, 1073741824
    v_mov_b32 v3, v2
    v_mov_b32 v4, v2
    s_cmp_eq_u32 s23, 0
    s_cbranch_scc0 L_notleft
    v_subrev_u32 v16, 384, v2
    v_cmp_lt_u32 vcc, 1, v14
    s_nop 1
    v_cndmask_b32 v3, v17, v16, vcc
L_notleft:
    s_cmp_eq_u32 s23, 13
    s_cbranch_scc0 L_notright
    v_cmp_gt_u32 vcc, 2, v14
    s_nop 1
    v_cndmask_b32 v4, v17, v2, vcc
L_notright:
    v_lshlrev_b32 v5, 4, v1
    s_lshr_b32 s24, s2, 3
    s_add_u32 s25, s24, s20
    s_and_b32 s25, s25, 3
    s_mul_i32 s30, s25, 4608
    s_lshr_b32 s24, s24, 2
    s_add_u32 s25, s24, 0
    s_and_b32 s25, s25, 3
    s_lshl_b32 s25, s25, 10
    s_add_u32 s44, s25, s30
    s_add_u32 s25, s24, 1
    s_and_b32 s25, s25, 3
    s_lshl_b32 s25, s25, 10
    s_add_u32 s45, s25, s30
    s_add_u32 s25, s24, 2
    s_and_b32 s25, s25, 3
    s_lshl_b32 s25, s25, 10
    s_add_u32 s46, s25, s30
    s_add_u32 s25, s24, 3
    s_and_b32 s25, s25, 3
    s_lshl_b32 s25, s25, 10
    s_add_u32 s47, s25, s30
    s_add_u32 s48, s30, 4096
    s_mov_b32 s40, 0xf3ffcfff
    s_mov_b32 s41, 0x003ffcff
    s_waitcnt lgkmcnt(0)
    s_mov_b32 s8, s4
    s_mov_b32 s9, s5
    s_mov_b32 s10, 9633792
    s_mov_b32 s11, 0x00020000
    s_mov_b32 s12, s6
    s_mov_b32 s13, s7
    s_mov_b32 s14, 165888
    s_mov_b32 s15, 0x00020000
    s_mov_b32 s16, s34
    s_mov_b32 s17, s35
    s_mov_b32 s18, 9633792
    s_mov_b32 s19, 0x00020000
    s_add_u32 m0, s44, 89600
    s_add_u32 s26, s44, 0
    buffer_load_dwordx4 v5, s[12:15], s26 offen lds
    s_add_u32 m0, s45, 89600
    s_add_u32 s26, s45, 0
    buffer_load_dwordx4 v5, s[12:15], s26 offen lds
    s_add_u32 m0, s46, 89600
    s_add_u32 s26, s46, 0
    buffer_load_dwordx4 v5, s[12:15], s26 offen lds
    s_add_u32 m0, s47, 89600
    s_add_u32 s26, s47, 0
    buffer_load_dwordx4 v5, s[12:15], s26 offen lds
    s_mov_b32 exec_hi, 0
    s_add_u32 m0, s48, 89600
    s_add_u32 s26, s48, 0
    buffer_load_dwordx4 v5, s[12:15], s26 offen lds
    s_mov_b32 exec_hi, -1
    s_add_u32 s24, s20, 0
    s_add_u32 s25, s24, s21
    s_sub_u32 s25, s25, 2
    s_mul_i32 s26, s25, 224
    s_add_u32 s26, s26, s22
    s_sub_u32 s26, s26, 2
    s_mul_i32 s29, s26, 192
    s_cmp_lt_u32 s25, 224
    s_cselect_b32 s29, s29, s32
    s_mul_i32 s36, s24, 4480
    s_mov_b64 exec, s[40:41]
    s_mov_b32 m0, s36
    s_add_u32 s26, s29, s33
    buffer_load_dwordx4 v3, s[8:11], s26 offen lds
    s_mov_b64 exec, -1
    s_mov_b64 exec, s[40:41]
    s_add_u32 m0, s36, 896
    s_add_u32 s26, s29, 768
    buffer_load_dwordx4 v2, s[8:11], s26 offen lds
    s_mov_b64 exec, -1
    s_mov_b64 exec, s[40:41]
    s_add_u32 m0, s36, 1792
    s_add_u32 s26, s29, 1536
    buffer_load_dwordx4 v2, s[8:11], s26 offen lds
    s_mov_b64 exec, -1
    s_mov_b64 exec, s[40:41]
    s_add_u32 m0, s36, 2688
    s_add_u32 s26, s29, 2304
    buffer_load_dwordx4 v2, s[8:11], s26 offen lds
    s_mov_b64 exec, -1
    s_mov_b64 exec, s[40:41]
    s_add_u32 m0, s36, 3584
    s_add_u32 s26, s29, 3072
    buffer_load_dwordx4 v4, s[8:11], s26 offen lds
    s_mov_b64 exec, -1
    s_add_u32 m0, s44, 108032
    s_add_u32 s26, s44, 18432
    buffer_load_dwordx4 v5, s[12:15], s26 offen lds
    s_add_u32 m0, s45, 108032
    s_add_u32 s26, s45, 18432
    buffer_load_dwordx4 v5, s[12:15], s26 offen lds
    s_add_u32 m0, s46, 108032
    s_add_u32 s26, s46, 18432
    buffer_load_dwordx4 v5, s[12:15], s26 offen lds
    s_add_u32 m0, s47, 108032
    s_add_u32 s26, s47, 18432
    buffer_load_dwordx4 v5, s[12:15], s26 offen lds
    s_mov_b32 exec_hi, 0
    s_add_u32 m0, s48, 108032
    s_add_u32 s26, s48, 18432
    buffer_load_dwordx4 v5, s[12:15], s26 offen lds
    s_mov_b32 exec_hi, -1
    s_add_u32 s24, s20, 4
    s_add_u32 s25, s24, s21
    s_sub_u32 s25, s25, 2
    s_mul_i32 s26, s25, 224
    s_add_u32 s26, s26, s22
    s_sub_u32 s26, s26, 2
    s_mul_i32 s29, s26, 192
    s_cmp_lt_u32 s25, 224
    s_cselect_b32 s29, s29, s32
    s_mul_i32 s36, s24, 4480
    s_mov_b64 exec, s[40:41]
    s_mov_b32 m0, s36
    s_add_u32 s26, s29, s33
    buffer_load_dwordx4 v3, s[8:11], s26 offen lds
    s_mov_b64 exec, -1
    s_mov_b64 exec, s[40:41]
    s_add_u32 m0, s36, 896
    s_add_u32 s26, s29, 768
    buffer_load_dwordx4 v2, s[8:11], s26 offen lds
    s_mov_b64 exec, -1
    s_mov_b64 exec, s[40:41]
    s_add_u32 m0, s36, 1792
    s_add_u32 s26, s29, 1536
    buffer_load_dwordx4 v2, s[8:11], s26 offen lds
    s_mov_b64 exec, -1
    s_mov_b64 exec, s[40:41]
    s_add_u32 m0, s36, 2688
    s_add_u32 s26, s29, 2304
    buffer_load_dwordx4 v2, s[8:11], s26 offen lds
    s_mov_b64 exec, -1
    s_mov_b64 exec, s[40:41]
    s_add_u32 m0, s36, 3584
    s_add_u32 s26, s29, 3072
    buffer_load_dwordx4 v4, s[8:11], s26 offen lds
    s_mov_b64 exec, -1
    v_and_b32 v14, 15, v1
    v_lshrrev_b32 v15, 4, v1
    s_and_b32 s24, s20, 1
    s_mul_i32 s24, s24, 4480
    v_mul_u32_u24 v6, 224, v14
    v_lshl_add_u32 v6, v15, 4, v6
    v_add_u32 v6, s24, v6
    v_add_u32 v7, 35840, v6
    v_lshrrev_b32 v16, 2, v14
    v_and_b32 v17, 3, v14
    v_lshl_add_u32 v16, v15, 3, v16
    v_mul_u32_u24 v16, 192, v16
    s_lshr_b32 s25, s20, 1
    s_mul_i32 s25, s25, 96
    s_add_u32 s25, s25, 89600
    v_add_u32 v16, s25, v16
    v_lshl_add_u32 v8, v17, 4, v16
    v_lshl_add_u32 v9, v17, 3, v16
    v_add_u32 v9, 64, v9
    v_add_u32 v10, 36864, v8
    v_add_u32 v11, 36864, v9
    v_mul_u32_u24 v12, 192, v14
    s_lshr_b32 s25, s20, 1
    s_mul_i32 s25, s25, 96
    v_add_u32 v12, s25, v12
    v_lshl_add_u32 v13, v15, 3, v12
    v_add_u32 v13, 64, v13
    v_lshl_add_u32 v12, v15, 4, v12
    s_and_b32 s24, s20, 1
    s_add_u32 s24, s24, s21
    s_mul_i32 s24, s24, 224
    s_add_u32 s24, s24, s22
    s_mul_i32 s31, s24, 192
    s_waitcnt vmcnt(10)
    s_barrier
    ds_read_b64_tr_b16 a[0:1], v8 offset:0
    ds_read_b64_tr_b16 a[2:3], v8 offset:768
    ds_read_b64_tr_b16 a[4:5], v8 offset:8
    ds_read_b64_tr_b16 a[6:7], v8 offset:776
    ds_read_b64_tr_b16 a[8:9], v9 offset:0
    ds_read_b64_tr_b16 a[10:11], v9 offset:768
    ds_read_b128 v[116:119], v6 offset:0
    ds_read_b128 v[120:123], v6 offset:8960
    s_waitcnt lgkmcnt(0)
    v_mfma_f32_16x16x32_bf16 v[32:35], a[0:3], v[116:119], 0
    ds_read_b64_tr_b16 a[12:13], v8 offset:6144
    v_mfma_f32_16x16x32_bf16 v[36:39], a[4:7], v[116:119], 0
    ds_read_b64_tr_b16 a[14:15], v8 offset:6912
    v_mfma_f32_16x16x32_bf16 v[40:43], a[8:11], v[116:119], 0
    ds_read_b64_tr_b16 a[16:17], v8 offset:6152
    v_mfma_f32_16x16x32_bf16 v[44:47], a[0:3], v[120:123], 0
    ds_read_b64_tr_b16 a[18:19], v8 offset:6920
    v_mfma_f32_16x16x32_bf16 v[48:51], a[4:7], v[120:123], 0
    ds_read_b64_tr_b16 a[20:21], v9 offset:6144
    s_add_u32 m0, s44, 126464
    s_add_u32 s26, s44, 36864
    buffer_load_dwordx4 v5, s[12:15], s26 offen lds
    v_mfma_f32_16x16x32_bf16 v[52:55], a[8:11], v[120:123], 0
    ds_read_b64_tr_b16 a[22:23], v9 offset:6912
    ds_read_b128 v[144:147], v6 offset:64
    ds_read_b128 v[148:151], v6 offset:9024
    s_waitcnt lgkmcnt(0)
    v_mfma_f32_16x16x32_bf16 v[32:35], a[12:15], v[144:147], v[32:35]
    ds_read_b64_tr_b16 a[24:25], v8 offset:12288
    v_mfma_f32_16x16x32_bf16 v[36:39], a[16:19], v[144:147], v[36:39]
    ds_read_b64_tr_b16 a[26:27], v8 offset:13056
    v_mfma_f32_16x16x32_bf16 v[40:43], a[20:23], v[144:147], v[40:43]
    ds_read_b64_tr_b16 a[28:29], v8 offset:12296
    v_mfma_f32_16x16x32_bf16 v[44:47], a[12:15], v[148:151], v[44:47]
    ds_read_b64_tr_b16 a[30:31], v8 offset:13064
    s_add_u32 m0, s45, 126464
    s_add_u32 s26, s45, 36864
    buffer_load_dwordx4 v5, s[12:15], s26 offen lds
    v_mfma_f32_16x16x32_bf16 v[48:51], a[16:19], v[148:151], v[48:51]
    ds_read_b64_tr_b16 a[32:33], v9 offset:12288
    v_mfma_f32_16x16x32_bf16 v[52:55], a[20:23], v[148:151], v[52:55]
    ds_read_b64_tr_b16 a[34:35], v9 offset:13056
    ds_read_b128 v[116:119], v6 offset:128
    ds_read_b128 v[120:123], v6 offset:9088
    s_add_u32 m0, s46, 126464
    s_add_u32 s26, s46, 36864
    buffer_load_dwordx4 v5, s[12:15], s26 offen lds
    s_add_u32 m0, s47, 126464
    s_add_u32 s26, s47, 36864
    buffer_load_dwordx4 v5, s[12:15], s26 offen lds
    s_mov_b32 exec_hi, 0
    s_add_u32 m0, s48, 126464
    s_add_u32 s26, s48, 36864
    buffer_load_dwordx4 v5, s[12:15], s26 offen lds
    s_mov_b32 exec_hi, -1
    s_waitcnt vmcnt(10)
    s_barrier
    s_waitcnt lgkmcnt(0)
    v_mfma_f32_16x16x32_bf16 v[32:35], a[24:27], v[116:119], v[32:35]
    ds_read_b64_tr_b16 a[36:37], v8 offset:18432
    v_mfma_f32_16x16x32_bf16 v[36:39], a[28:31], v[116:119], v[36:39]
    ds_read_b64_tr_b16 a[38:39], v8 offset:19200
    v_mfma_f32_16x16x32_bf16 v[40:43], a[32:35], v[116:119], v[40:43]
    ds_read_b64_tr_b16 a[40:41], v8 offset:18440
    s_add_u32 s24, s20, 8
    s_add_u32 s25, s24, s21
    s_sub_u32 s25, s25, 2
    s_mul_i32 s26, s25, 224
    s_add_u32 s26, s26, s22
    s_sub_u32 s26, s26, 2
    s_mul_i32 s29, s26, 192
    s_cmp_lt_u32 s25, 224
    s_cselect_b32 s29, s29, s32
    s_mul_i32 s36, s24, 4480
    s_mov_b64 exec, s[40:41]
    s_mov_b32 m0, s36
    s_add_u32 s26, s29, s33
    buffer_load_dwordx4 v3, s[8:11], s26 offen lds
    s_mov_b64 exec, -1
    v_mfma_f32_16x16x32_bf16 v[44:47], a[24:27], v[120:123], v[44:47]
    ds_read_b64_tr_b16 a[42:43], v8 offset:19208
    v_mfma_f32_16x16x32_bf16 v[48:51], a[28:31], v[120:123], v[48:51]
    ds_read_b64_tr_b16 a[44:45], v9 offset:18432
    v_mfma_f32_16x16x32_bf16 v[52:55], a[32:35], v[120:123], v[52:55]
    ds_read_b64_tr_b16 a[46:47], v9 offset:19200
    ds_read_b128 v[144:147], v6 offset:448
    ds_read_b128 v[148:151], v6 offset:9408
    s_waitcnt lgkmcnt(0)
    v_mfma_f32_16x16x32_bf16 v[32:35], a[36:39], v[144:147], v[32:35]
    ds_read_b64_tr_b16 a[48:49], v8 offset:24576
    v_mfma_f32_16x16x32_bf16 v[36:39], a[40:43], v[144:147], v[36:39]
    ds_read_b64_tr_b16 a[50:51], v8 offset:25344
    s_mov_b64 exec, s[40:41]
    s_add_u32 m0, s36, 896
    s_add_u32 s26, s29, 768
    buffer_load_dwordx4 v2, s[8:11], s26 offen lds
    s_mov_b64 exec, -1
    v_mfma_f32_16x16x32_bf16 v[40:43], a[44:47], v[144:147], v[40:43]
    ds_read_b64_tr_b16 a[52:53], v8 offset:24584
    v_mfma_f32_16x16x32_bf16 v[44:47], a[36:39], v[148:151], v[44:47]
    ds_read_b64_tr_b16 a[54:55], v8 offset:25352
    v_mfma_f32_16x16x32_bf16 v[48:51], a[40:43], v[148:151], v[48:51]
    ds_read_b64_tr_b16 a[56:57], v9 offset:24576
    v_mfma_f32_16x16x32_bf16 v[52:55], a[44:47], v[148:151], v[52:55]
    ds_read_b64_tr_b16 a[58:59], v9 offset:25344
    ds_read_b128 v[116:119], v6 offset:512
    ds_read_b128 v[120:123], v6 offset:9472
    s_waitcnt lgkmcnt(0)
    v_mfma_f32_16x16x32_bf16 v[32:35], a[48:51], v[116:119], v[32:35]
    ds_read_b64_tr_b16 a[60:61], v8 offset:30720
    s_mov_b64 exec, s[40:41]
    s_add_u32 m0, s36, 1792
    s_add_u32 s26, s29, 1536
    buffer_load_dwordx4 v2, s[8:11], s26 offen lds
    s_mov_b64 exec, -1
    v_mfma_f32_16x16x32_bf16 v[36:39], a[52:55], v[116:119], v[36:39]
    ds_read_b64_tr_b16 a[62:63], v8 offset:31488
    v_mfma_f32_16x16x32_bf16 v[40:43], a[56:59], v[116:119], v[40:43]
    ds_read_b64_tr_b16 a[64:65], v8 offset:30728
    v_mfma_f32_16x16x32_bf16 v[44:47], a[48:51], v[120:123], v[44:47]
    ds_read_b64_tr_b16 a[66:67], v8 offset:31496
    v_mfma_f32_16x16x32_bf16 v[48:51], a[52:55], v[120:123], v[48:51]
    ds_read_b64_tr_b16 a[68:69], v9 offset:30720
    v_mfma_f32_16x16x32_bf16 v[52:55], a[56:59], v[120:123], v[52:55]
    ds_read_b64_tr_b16 a[70:71], v9 offset:31488
    ds_read_b128 v[144:147], v6 offset:576
    ds_read_b128 v[148:151], v6 offset:9536
    s_mov_b64 exec, s[40:41]
    s_add_u32 m0, s36, 2688
    s_add_u32 s26, s29, 2304
    buffer_load_dwordx4 v2, s[8:11], s26 offen lds
    s_mov_b64 exec, -1
    s_waitcnt vmcnt(9)
    s_barrier
    s_waitcnt lgkmcnt(0)
    v_mfma_f32_16x16x32_bf16 v[32:35], a[60:63], v[144:147], v[32:35]
    ds_read_b128 v[116:119], v6 offset:17920
    v_mfma_f32_16x16x32_bf16 v[36:39], a[64:67], v[144:147], v[36:39]
    ds_read_b128 v[120:123], v6 offset:26880
    v_mfma_f32_16x16x32_bf16 v[40:43], a[68:71], v[144:147], v[40:43]
    v_mfma_f32_16x16x32_bf16 v[44:47], a[60:63], v[148:151], v[44:47]
    v_mfma_f32_16x16x32_bf16 v[48:51], a[64:67], v[148:151], v[48:51]
    s_add_u32 m0, s44, 89600
    s_add_u32 s26, s44, 73728
    buffer_load_dwordx4 v5, s[12:15], s26 offen lds
    v_mfma_f32_16x16x32_bf16 v[52:55], a[68:71], v[148:151], v[52:55]
    s_waitcnt lgkmcnt(0)
    v_mfma_f32_16x16x32_bf16 v[56:59], a[0:3], v[116:119], 0
    ds_read_b128 v[144:147], v6 offset:17984
    v_mfma_f32_16x16x32_bf16 v[60:63], a[4:7], v[116:119], 0
    ds_read_b128 v[148:151], v6 offset:26944
    v_mfma_f32_16x16x32_bf16 v[64:67], a[8:11], v[116:119], 0
    v_mfma_f32_16x16x32_bf16 v[68:71], a[0:3], v[120:123], 0
    s_add_u32 m0, s45, 89600
    s_add_u32 s26, s45, 73728
    buffer_load_dwordx4 v5, s[12:15], s26 offen lds
    v_mfma_f32_16x16x32_bf16 v[72:75], a[4:7], v[120:123], 0
    v_mfma_f32_16x16x32_bf16 v[76:79], a[8:11], v[120:123], 0
    s_waitcnt lgkmcnt(0)
    v_mfma_f32_16x16x32_bf16 v[56:59], a[12:15], v[144:147], v[56:59]
    ds_read_b128 v[116:119], v6 offset:18048
    v_mfma_f32_16x16x32_bf16 v[60:63], a[16:19], v[144:147], v[60:63]
    ds_read_b128 v[120:123], v6 offset:27008
    v_mfma_f32_16x16x32_bf16 v[64:67], a[20:23], v[144:147], v[64:67]
    s_add_u32 m0, s46, 89600
    s_add_u32 s26, s46, 73728
    buffer_load_dwordx4 v5, s[12:15], s26 offen lds
    v_mfma_f32_16x16x32_bf16 v[68:71], a[12:15], v[148:151], v[68:71]
    v_mfma_f32_16x16x32_bf16 v[72:75], a[16:19], v[148:151], v[72:75]
    v_mfma_f32_16x16x32_bf16 v[76:79], a[20:23], v[148:151], v[76:79]
    s_waitcnt lgkmcnt(0)
    v_mfma_f32_16x16x32_bf16 v[56:59], a[24:27], v[116:119], v[56:59]
    ds_read_b128 v[144:147], v6 offset:18368
    v_mfma_f32_16x16x32_bf16 v[60:63], a[28:31], v[116:119], v[60:63]
    ds_read_b128 v[148:151], v6 offset:27328
    s_add_u32 m0, s47, 89600
    s_add_u32 s26, s47, 73728
    buffer_load_dwordx4 v5, s[12:15], s26 offen lds
    v_mfma_f32_16x16x32_bf16 v[64:67], a[32:35], v[116:119], v[64:67]
    v_mfma_f32_16x16x32_bf16 v[68:71], a[24:27], v[120:123], v[68:71]
    v_mfma_f32_16x16x32_bf16 v[72:75], a[28:31], v[120:123], v[72:75]
    v_mfma_f32_16x16x32_bf16 v[76:79], a[32:35], v[120:123], v[76:79]
    s_waitcnt lgkmcnt(0)
    v_mfma_f32_16x16x32_bf16 v[56:59], a[36:39], v[144:147], v[56:59]
    ds_read_b128 v[116:119], v6 offset:18432
    s_mov_b32 exec_hi, 0
    s_add_u32 m0, s48, 89600
    s_add_u32 s26, s48, 73728
    buffer_load_dwordx4 v5, s[12:15], s26 offen lds
    s_mov_b32 exec_hi, -1
    v_mfma_f32_16x16x32_bf16 v[60:63], a[40:43], v[144:147], v[60:63]
    ds_read_b128 v[120:123], v6 offset:27392
    v_mfma_f32_16x16x32_bf16 v[64:67], a[44:47], v[144:147], v[64:67]
    v_mfma_f32_16x16x32_bf16 v[68:71], a[36:39], v[148:151], v[68:71]
    v_mfma_f32_16x16x32_bf16 v[72:75], a[40:43], v[148:151], v[72:75]
    v_mfma_f32_16x16x32_bf16 v[76:79], a[44:47], v[148:151], v[76:79]
    s_mov_b64 exec, s[40:41]
    s_add_u32 m0, s36, 3584
    s_add_u32 s26, s29, 3072
    buffer_load_dwordx4 v4, s[8:11], s26 offen lds
    s_mov_b64 exec, -1
    s_waitcnt lgkmcnt(0)
    v_mfma_f32_16x16x32_bf16 v[56:59], a[48:51], v[116:119], v[56:59]
    ds_read_b128 v[144:147], v6 offset:18496
    v_mfma_f32_16x16x32_bf16 v[60:63], a[52:55], v[116:119], v[60:63]
    ds_read_b128 v[148:151], v6 offset:27456
    v_mfma_f32_16x16x32_bf16 v[64:67], a[56:59], v[116:119], v[64:67]
    v_mfma_f32_16x16x32_bf16 v[68:71], a[48:51], v[120:123], v[68:71]
    v_mfma_f32_16x16x32_bf16 v[72:75], a[52:55], v[120:123], v[72:75]
    s_add_u32 m0, s44, 144896
    s_add_u32 s26, s44, 55296
    buffer_load_dwordx4 v5, s[12:15], s26 offen lds
    v_mfma_f32_16x16x32_bf16 v[76:79], a[56:59], v[120:123], v[76:79]
    s_add_u32 m0, s45, 144896
    s_add_u32 s26, s45, 55296
    buffer_load_dwordx4 v5, s[12:15], s26 offen lds
    s_add_u32 m0, s46, 144896
    s_add_u32 s26, s46, 55296
    buffer_load_dwordx4 v5, s[12:15], s26 offen lds
    s_add_u32 m0, s47, 144896
    s_add_u32 s26, s47, 55296
    buffer_load_dwordx4 v5, s[12:15], s26 offen lds
    s_mov_b32 exec_hi, 0
    s_add_u32 m0, s48, 144896
    s_add_u32 s26, s48, 55296
    buffer_load_dwordx4 v5, s[12:15], s26 offen lds
    s_mov_b32 exec_hi, -1
    s_waitcnt vmcnt(15)
    s_barrier
    s_waitcnt lgkmcnt(0)
    v_mfma_f32_16x16x32_bf16 v[56:59], a[60:63], v[144:147], v[56:59]
    ds_read_b64_tr_b16 a[72:73], v10 offset:0
    v_mfma_f32_16x16x32_bf16 v[60:63], a[64:67], v[144:147], v[60:63]
    ds_read_b64_tr_b16 a[74:75], v10 offset:768
    v_mfma_f32_16x16x32_bf16 v[64:67], a[68:71], v[144:147], v[64:67]
    ds_read_b64_tr_b16 a[76:77], v10 offset:8
    v_mfma_f32_16x16x32_bf16 v[68:71], a[60:63], v[148:151], v[68:71]
    ds_read_b64_tr_b16 a[78:79], v10 offset:776
    s_add_u32 m0, s44, 108032
    s_add_u32 s26, s44, 92160
    buffer_load_dwordx4 v5, s[12:15], s26 offen lds
    v_mfma_f32_16x16x32_bf16 v[72:75], a[64:67], v[148:151], v[72:75]
    ds_read_b64_tr_b16 a[80:81], v11 offset:0
    v_mfma_f32_16x16x32_bf16 v[76:79], a[68:71], v[148:151], v[76:79]
    ds_read_b64_tr_b16 a[82:83], v11 offset:768
    ds_read_b128 v[116:119], v6 offset:896
    ds_read_b128 v[120:123], v6 offset:9856
    ds_read_b128 v[124:127], v6 offset:18816
    ds_read_b128 v[128:131], v6 offset:27776
    s_waitcnt lgkmcnt(0)
    v_mfma_f32_16x16x32_bf16 v[32:35], a[72:75], v[116:119], v[32:35]
    ds_read_b64_tr_b16 a[84:85], v10 offset:6144
    v_mfma_f32_16x16x32_bf16 v[36:39], a[76:79], v[116:119], v[36:39]
    ds_read_b64_tr_b16 a[86:87], v10 offset:6912
    v_mfma_f32_16x16x32_bf16 v[40:43], a[80:83], v[116:119], v[40:43]
    ds_read_b64_tr_b16 a[88:89], v10 offset:6152
    s_add_u32 m0, s45, 108032
    s_add_u32 s26, s45, 92160
    buffer_load_dwordx4 v5, s[12:15], s26 offen lds
    v_mfma_f32_16x16x32_bf16 v[44:47], a[72:75], v[120:123], v[44:47]
    ds_read_b64_tr_b16 a[90:91], v10 offset:6920
    v_mfma_f32_16x16x32_bf16 v[48:51], a[76:79], v[120:123], v[48:51]
    ds_read_b64_tr_b16 a[92:93], v11 offset:6144
    v_mfma_f32_16x16x32_bf16 v[52:55], a[80:83], v[120:123], v[52:55]
    ds_read_b64_tr_b16 a[94:95], v11 offset:6912
    v_mfma_f32_16x16x32_bf16 v[56:59], a[72:75], v[124:127], v[56:59]
    ds_read_b128 v[144:147], v6 offset:960
    v_mfma_f32_16x16x32_bf16 v[60:63], a[76:79], v[124:127], v[60:63]
    ds_read_b128 v[148:151], v6 offset:9920
    s_add_u32 m0, s46, 108032
    s_add_u32 s26, s46, 92160
    buffer_load_dwordx4 v5, s[12:15], s26 offen lds
    v_mfma_f32_16x16x32_bf16 v[64:67], a[80:83], v[124:127], v[64:67]
    ds_read_b128 v[152:155], v6 offset:18880
    v_mfma_f32_16x16x32_bf16 v[68:71], a[72:75], v[128:131], v[68:71]
    ds_read_b128 v[156:159], v6 offset:27840
    v_mfma_f32_16x16x32_bf16 v[72:75], a[76:79], v[128:131], v[72:75]
    v_mfma_f32_16x16x32_bf16 v[76:79], a[80:83], v[128:131], v[76:79]
    s_waitcnt lgkmcnt(0)
    v_mfma_f32_16x16x32_bf16 v[32:35], a[84:87], v[144:147], v[32:35]
    ds_read_b64_tr_b16 a[96:97], v10 offset:12288
    s_add_u32 m0, s47, 108032
    s_add_u32 s26, s47, 92160
    buffer_load_dwordx4 v5, s[12:15], s26 offen lds
    v_mfma_f32_16x16x32_bf16 v[36:39], a[88:91], v[144:147], v[36:39]
    ds_read_b64_tr_b16 a[98:99], v10 offset:13056
    v_mfma_f32_16x16x32_bf16 v[40:43], a[92:95], v[144:147], v[40:43]
    ds_read_b64_tr_b16 a[100:101], v10 offset:12296
    v_mfma_f32_16x16x32_bf16 v[44:47], a[84:87], v[148:151], v[44:47]
    ds_read_b64_tr_b16 a[102:103], v10 offset:13064
    v_mfma_f32_16x16x32_bf16 v[48:51], a[88:91], v[148:151], v[48:51]
    ds_read_b64_tr_b16 a[104:105], v11 offset:12288
    v_mfma_f32_16x16x32_bf16 v[52:55], a[92:95], v[148:151], v[52:55]
    ds_read_b64_tr_b16 a[106:107], v11 offset:13056
    s_mov_b32 exec_hi, 0
    s_add_u32 m0, s48, 108032
    s_add_u32 s26, s48, 92160
    buffer_load_dwordx4 v5, s[12:15], s26 offen lds
    s_mov_b32 exec_hi, -1
    v_mfma_f32_16x16x32_bf16 v[56:59], a[84:87], v[152:155], v[56:59]
    ds_read_b128 v[116:119], v6 offset:1024
    v_mfma_f32_16x16x32_bf16 v[60:63], a[88:91], v[152:155], v[60:63]
    ds_read_b128 v[120:123], v6 offset:9984
    v_mfma_f32_16x16x32_bf16 v[64:67], a[92:95], v[152:155], v[64:67]
    ds_read_b128 v[124:127], v6 offset:18944
    v_mfma_f32_16x16x32_bf16 v[68:71], a[84:87], v[156:159], v[68:71]
    ds_read_b128 v[128:131], v6 offset:27904
    v_mfma_f32_16x16x32_bf16 v[72:75], a[88:91], v[156:159], v[72:75]
    s_add_u32 s24, s20, 12
    s_add_u32 s25, s24, s21
    s_sub_u32 s25, s25, 2
    s_mul_i32 s26, s25, 224
    s_add_u32 s26, s26, s22
    s_sub_u32 s26, s26, 2
    s_mul_i32 s29, s26, 192
    s_cmp_lt_u32 s25, 224
    s_cselect_b32 s29, s29, s32
    s_mul_i32 s36, s24, 4480
    s_mov_b64 exec, s[40:41]
    s_mov_b32 m0, s36
    s_add_u32 s26, s29, s33
    buffer_load_dwordx4 v3, s[8:11], s26 offen lds
    s_mov_b64 exec, -1
    v_mfma_f32_16x16x32_bf16 v[76:79], a[92:95], v[156:159], v[76:79]
    s_mov_b64 exec, s[40:41]
    s_add_u32 m0, s36, 896
    s_add_u32 s26, s29, 768
    buffer_load_dwordx4 v2, s[8:11], s26 offen lds
    s_mov_b64 exec, -1
    s_waitcnt vmcnt(12)
    s_barrier
    s_waitcnt lgkmcnt(0)
    v_mfma_f32_16x16x32_bf16 v[32:35], a[96:99], v[116:119], v[32:35]
    ds_read_b128 v[144:147], v7 offset:0
    v_mfma_f32_16x16x32_bf16 v[36:39], a[100:103], v[116:119], v[36:39]
    ds_read_b128 v[148:151], v7 offset:8960
    v_mfma_f32_16x16x32_bf16 v[40:43], a[104:107], v[116:119], v[40:43]
    v_mfma_f32_16x16x32_bf16 v[44:47], a[96:99], v[120:123], v[44:47]
    s_mov_b64 exec, s[40:41]
    s_add_u32 m0, s36, 1792
    s_add_u32 s26, s29, 1536
    buffer_load_dwordx4 v2, s[8:11], s26 offen lds
    s_mov_b64 exec, -1
    v_mfma_f32_16x16x32_bf16 v[48:51], a[100:103], v[120:123], v[48:51]
    v_mfma_f32_16x16x32_bf16 v[52:55], a[104:107], v[120:123], v[52:55]
    v_mfma_f32_16x16x32_bf16 v[56:59], a[96:99], v[124:127], v[56:59]
    v_mfma_f32_16x16x32_bf16 v[60:63], a[100:103], v[124:127], v[60:63]
    v_mfma_f32_16x16x32_bf16 v[64:67], a[104:107], v[124:127], v[64:67]
    s_mov_b64 exec, s[40:41]
    s_add_u32 m0, s36, 2688
    s_add_u32 s26, s29, 2304
    buffer_load_dwordx4 v2, s[8:11], s26 offen lds
    s_mov_b64 exec, -1
    v_mfma_f32_16x16x32_bf16 v[68:71], a[96:99], v[128:131], v[68:71]
    v_mfma_f32_16x16x32_bf16 v[72:75], a[100:103], v[128:131], v[72:75]
    v_mfma_f32_16x16x32_bf16 v[76:79], a[104:107], v[128:131], v[76:79]
    s_waitcnt lgkmcnt(0)
    v_mfma_f32_16x16x32_bf16 v[80:83], a[0:3], v[144:147], 0
    ds_read_b128 v[116:119], v7 offset:64
    v_mfma_f32_16x16x32_bf16 v[84:87], a[4:7], v[144:147], 0
    ds_read_b128 v[120:123], v7 offset:9024
    s_mov_b64 exec, s[40:41]
    s_add_u32 m0, s36, 3584
    s_add_u32 s26, s29, 3072
    buffer_load_dwordx4 v4, s[8:11], s26 offen lds
    s_mov_b64 exec, -1
    v_mfma_f32_16x16x32_bf16 v[88:91], a[8:11], v[144:147], 0
    v_mfma_f32_16x16x32_bf16 v[92:95], a[0:3], v[148:151], 0
    v_mfma_f32_16x16x32_bf16 v[96:99], a[4:7], v[148:151], 0
    v_mfma_f32_16x16x32_bf16 v[100:103], a[8:11], v[148:151], 0
    s_waitcnt lgkmcnt(0)
    v_mfma_f32_16x16x32_bf16 v[80:83], a[12:15], v[116:119], v[80:83]
    ds_read_b128 v[144:147], v7 offset:128
    s_add_u32 s24, s20, 16
    s_add_u32 s25, s24, s21
    s_sub_u32 s25, s25, 2
    s_mul_i32 s26, s25, 224
    s_add_u32 s26, s26, s22
    s_sub_u32 s26, s26, 2
    s_mul_i32 s29, s26, 192
    s_cmp_lt_u32 s25, 224
    s_cselect_b32 s29, s29, s32
    s_cmp_lt_u32 s24, 18
    s_cselect_b32 s29, s29, s32
    s_mul_i32 s36, s24, 4480
    s_mov_b64 exec, s[40:41]
    s_mov_b32 m0, s36
    s_add_u32 s26, s29, s33
    buffer_load_dwordx4 v3, s[8:11], s26 offen lds
    s_mov_b64 exec, -1
    v_mfma_f32_16x16x32_bf16 v[84:87], a[16:19], v[116:119], v[84:87]
    ds_read_b128 v[148:151], v7 offset:9088
    v_mfma_f32_16x16x32_bf16 v[88:91], a[20:23], v[116:119], v[88:91]
    v_mfma_f32_16x16x32_bf16 v[92:95], a[12:15], v[120:123], v[92:95]
    v_mfma_f32_16x16x32_bf16 v[96:99], a[16:19], v[120:123], v[96:99]
    v_mfma_f32_16x16x32_bf16 v[100:103], a[20:23], v[120:123], v[100:103]
    s_mov_b64 exec, s[40:41]
    s_add_u32 m0, s36, 896
    s_add_u32 s26, s29, 768
    buffer_load_dwordx4 v2, s[8:11], s26 offen lds
    s_mov_b64 exec, -1
    s_waitcnt lgkmcnt(0)
    v_mfma_f32_16x16x32_bf16 v[80:83], a[24:27], v[144:147], v[80:83]
    ds_read_b128 v[116:119], v7 offset:448
    v_mfma_f32_16x16x32_bf16 v[84:87], a[28:31], v[144:147], v[84:87]
    ds_read_b128 v[120:123], v7 offset:9408
    v_mfma_f32_16x16x32_bf16 v[88:91], a[32:35], v[144:147], v[88:91]
    v_mfma_f32_16x16x32_bf16 v[92:95], a[24:27], v[148:151], v[92:95]
    v_mfma_f32_16x16x32_bf16 v[96:99], a[28:31], v[148:151], v[96:99]
    s_mov_b64 exec, s[40:41]
    s_add_u32 m0, s36, 1792
    s_add_u32 s26, s29, 1536
    buffer_load_dwordx4 v2, s[8:11], s26 offen lds
    s_mov_b64 exec, -1
    v_mfma_f32_16x16x32_bf16 v[100:103], a[32:35], v[148:151], v[100:103]
    s_waitcnt lgkmcnt(0)
    v_mfma_f32_16x16x32_bf16 v[80:83], a[36:39], v[116:119], v[80:83]
    ds_read_b128 v[144:147], v7 offset:512
    v_mfma_f32_16x16x32_bf16 v[84:87], a[40:43], v[116:119], v[84:87]
    ds_read_b128 v[148:151], v7 offset:9472
    v_mfma_f32_16x16x32_bf16 v[88:91], a[44:47], v[116:119], v[88:91]
    v_mfma_f32_16x16x32_bf16 v[92:95], a[36:39], v[120:123], v[92:95]
    s_mov_b64 exec, s[40:41]
    s_add_u32 m0, s36, 2688
    s_add_u32 s26, s29, 2304
    buffer_load_dwordx4 v2, s[8:11], s26 offen lds
    s_mov_b64 exec, -1
    v_mfma_f32_16x16x32_bf16 v[96:99], a[40:43], v[120:123], v[96:99]
    v_mfma_f32_16x16x32_bf16 v[100:103], a[44:47], v[120:123], v[100:103]
    s_waitcnt lgkmcnt(0)
    v_mfma_f32_16x16x32_bf16 v[80:83], a[48:51], v[144:147], v[80:83]
    ds_read_b128 v[116:119], v7 offset:576
    v_mfma_f32_16x16x32_bf16 v[84:87], a[52:55], v[144:147], v[84:87]
    ds_read_b128 v[120:123], v7 offset:9536
    v_mfma_f32_16x16x32_bf16 v[88:91], a[56:59], v[144:147], v[88:91]
    s_mov_b64 exec, s[40:41]
    s_add_u32 m0, s36, 3584
    s_add_u32 s26, s29, 3072
    buffer_load_dwordx4 v4, s[8:11], s26 offen lds
    s_mov_b64 exec, -1
    v_mfma_f32_16x16x32_bf16 v[92:95], a[48:51], v[148:151], v[92:95]
    v_mfma_f32_16x16x32_bf16 v[96:99], a[52:55], v[148:151], v[96:99]
    v_mfma_f32_16x16x32_bf16 v[100:103], a[56:59], v[148:151], v[100:103]
    s_waitcnt lgkmcnt(0)
    v_mfma_f32_16x16x32_bf16 v[80:83], a[60:63], v[116:119], v[80:83]
    ds_read_b128 v[144:147], v7 offset:896
    v_mfma_f32_16x16x32_bf16 v[84:87], a[64:67], v[116:119], v[84:87]
    ds_read_b128 v[148:151], v7 offset:9856
    v_mfma_f32_16x16x32_bf16 v[88:91], a[68:71], v[116:119], v[88:91]
    v_mfma_f32_16x16x32_bf16 v[92:95], a[60:63], v[120:123], v[92:95]
    v_mfma_f32_16x16x32_bf16 v[96:99], a[64:67], v[120:123], v[96:99]
    v_mfma_f32_16x16x32_bf16 v[100:103], a[68:71], v[120:123], v[100:103]
    s_waitcnt lgkmcnt(0)
    v_mfma_f32_16x16x32_bf16 v[80:83], a[72:75], v[144:147], v[80:83]
    ds_read_b128 v[116:119], v7 offset:960
    v_mfma_f32_16x16x32_bf16 v[84:87], a[76:79], v[144:147], v[84:87]
    ds_read_b128 v[120:123], v7 offset:9920
    v_mfma_f32_16x16x32_bf16 v[88:91], a[80:83], v[144:147], v[88:91]
    v_mfma_f32_16x16x32_bf16 v[92:95], a[72:75], v[148:151], v[92:95]
    v_mfma_f32_16x16x32_bf16 v[96:99], a[76:79], v[148:151], v[96:99]
    v_mfma_f32_16x16x32_bf16 v[100:103], a[80:83], v[148:151], v[100:103]
    s_waitcnt lgkmcnt(0)
    v_mfma_f32_16x16x32_bf16 v[80:83], a[84:87], v[116:119], v[80:83]
    ds_read_b128 v[144:147], v7 offset:1024
    v_mfma_f32_16x16x32_bf16 v[84:87], a[88:91], v[116:119], v[84:87]
    ds_read_b128 v[148:151], v7 offset:9984
    v_mfma_f32_16x16x32_bf16 v[88:91], a[92:95], v[116:119], v[88:91]
    v_mfma_f32_16x16x32_bf16 v[92:95], a[84:87], v[120:123], v[92:95]
    v_mfma_f32_16x16x32_bf16 v[96:99], a[88:91], v[120:123], v[96:99]
    v_mfma_f32_16x16x32_bf16 v[100:103], a[92:95], v[120:123], v[100:103]
    s_waitcnt vmcnt(15)
    s_barrier
    s_waitcnt lgkmcnt(0)
    v_mfma_f32_16x16x32_bf16 v[80:83], a[96:99], v[144:147], v[80:83]
    ds_read_b64_tr_b16 a[108:109], v10 offset:18432
    v_mfma_f32_16x16x32_bf16 v[84:87], a[100:103], v[144:147], v[84:87]
    ds_read_b64_tr_b16 a[110:111], v10 offset:19200
    v_mfma_f32_16x16x32_bf16 v[88:91], a[104:107], v[144:147], v[88:91]
    ds_read_b64_tr_b16 a[112:113], v10 offset:18440
    v_mfma_f32_16x16x32_bf16 v[92:95], a[96:99], v[148:151], v[92:95]
    ds_read_b64_tr_b16 a[114:115], v10 offset:19208
    s_add_u32 m0, s44, 126464
    s_add_u32 s26, s44, 110592
    buffer_load_dwordx4 v5, s[12:15], s26 offen lds
    v_mfma_f32_16x16x32_bf16 v[96:99], a[100:103], v[148:151], v[96:99]
    ds_read_b64_tr_b16 a[116:117], v11 offset:18432
    v_mfma_f32_16x16x32_bf16 v[100:103], a[104:107], v[148:151], v[100:103]
    ds_read_b64_tr_b16 a[118:119], v11 offset:19200
    ds_read_b128 v[116:119], v6 offset:8960
    ds_read_b128 v[120:123], v6 offset:17920
    ds_read_b128 v[124:127], v6 offset:26880
    ds_read_b128 v[128:131], v6 offset:35840
    ds_read_b128 v[132:135], v7 offset:8960
    s_waitcnt lgkmcnt(0)
    v_mfma_f32_16x16x32_bf16 v[32:35], a[108:111], v[116:119], v[32:35]
    ds_read_b64_tr_b16 a[120:121], v10 offset:24576
    v_mfma_f32_16x16x32_bf16 v[36:39], a[112:115], v[116:119], v[36:39]
    ds_read_b64_tr_b16 a[122:123], v10 offset:25344
    v_mfma_f32_16x16x32_bf16 v[40:43], a[116:119], v[116:119], v[40:43]
    ds_read_b64_tr_b16 a[124:125], v10 offset:24584
    s_add_u32 m0, s45, 126464
    s_add_u32 s26, s45, 110592
    buffer_load_dwordx4 v5, s[12:15], s26 offen lds
    v_mfma_f32_16x16x32_bf16 v[44:47], a[108:111], v[120:123], v[44:47]
    ds_read_b64_tr_b16 a[126:127], v10 offset:25352
    v_mfma_f32_16x16x32_bf16 v[48:51], a[112:115], v[120:123], v[48:51]
    ds_read_b64_tr_b16 a[128:129], v11 offset:24576
    v_mfma_f32_16x16x32_bf16 v[52:55], a[116:119], v[120:123], v[52:55]
    ds_read_b64_tr_b16 a[130:131], v11 offset:25344
    v_mfma_f32_16x16x32_bf16 v[56:59], a[108:111], v[124:127], v[56:59]
    ds_read_b128 v[144:147], v6 offset:9024
    v_mfma_f32_16x16x32_bf16 v[60:63], a[112:115], v[124:127], v[60:63]
    ds_read_b128 v[148:151], v6 offset:17984
    s_add_u32 m0, s46, 126464
    s_add_u32 s26, s46, 110592
    buffer_load_dwordx4 v5, s[12:15], s26 offen lds
    v_mfma_f32_16x16x32_bf16 v[64:67], a[116:119], v[124:127], v[64:67]
    ds_read_b128 v[152:155], v6 offset:26944
    v_mfma_f32_16x16x32_bf16 v[68:71], a[108:111], v[128:131], v[68:71]
    ds_read_b128 v[156:159], v6 offset:35904
    v_mfma_f32_16x16x32_bf16 v[72:75], a[112:115], v[128:131], v[72:75]
    ds_read_b128 v[160:163], v7 offset:9024
    v_mfma_f32_16x16x32_bf16 v[76:79], a[116:119], v[128:131], v[76:79]
    v_mfma_f32_16x16x32_bf16 v[80:83], a[108:111], v[132:135], v[80:83]
    s_add_u32 m0, s47, 126464
    s_add_u32 s26, s47, 110592
    buffer_load_dwordx4 v5, s[12:15], s26 offen lds
    v_mfma_f32_16x16x32_bf16 v[84:87], a[112:115], v[132:135], v[84:87]
    v_mfma_f32_16x16x32_bf16 v[88:91], a[116:119], v[132:135], v[88:91]
    s_waitcnt lgkmcnt(0)
    v_mfma_f32_16x16x32_bf16 v[32:35], a[120:123], v[144:147], v[32:35]
    ds_read_b64_tr_b16 a[132:133], v10 offset:30720
    v_mfma_f32_16x16x32_bf16 v[36:39], a[124:127], v[144:147], v[36:39]
    ds_read_b64_tr_b16 a[134:135], v10 offset:31488
    v_mfma_f32_16x16x32_bf16 v[40:43], a[128:131], v[144:147], v[40:43]
    ds_read_b64_tr_b16 a[136:137], v10 offset:30728
    s_mov_b32 exec_hi, 0
    s_add_u32 m0, s48, 126464
    s_add_u32 s26, s48, 110592
    buffer_load_dwordx4 v5, s[12:15], s26 offen lds
    s_mov_b32 exec_hi, -1
    v_mfma_f32_16x16x32_bf16 v[44:47], a[120:123], v[148:151], v[44:47]
    ds_read_b64_tr_b16 a[138:139], v10 offset:31496
    v_mfma_f32_16x16x32_bf16 v[48:51], a[124:127], v[148:151], v[48:51]
    ds_read_b64_tr_b16 a[140:141], v11 offset:30720
    v_mfma_f32_16x16x32_bf16 v[52:55], a[128:131], v[148:151], v[52:55]
    ds_read_b64_tr_b16 a[142:143], v11 offset:31488
    v_mfma_f32_16x16x32_bf16 v[56:59], a[120:123], v[152:155], v[56:59]
    ds_read_b128 v[116:119], v6 offset:9088
    v_mfma_f32_16x16x32_bf16 v[60:63], a[124:127], v[152:155], v[60:63]
    ds_read_b128 v[120:123], v6 offset:18048
    v_mfma_f32_16x16x32_bf16 v[64:67], a[128:131], v[152:155], v[64:67]
    ds_read_b128 v[124:127], v6 offset:27008
    v_mfma_f32_16x16x32_bf16 v[68:71], a[120:123], v[156:159], v[68:71]
    ds_read_b128 v[128:131], v6 offset:35968
    v_mfma_f32_16x16x32_bf16 v[72:75], a[124:127], v[156:159], v[72:75]
    ds_read_b128 v[132:135], v7 offset:9088
    v_mfma_f32_16x16x32_bf16 v[76:79], a[128:131], v[156:159], v[76:79]
    v_mfma_f32_16x16x32_bf16 v[80:83], a[120:123], v[160:163], v[80:83]
    v_mfma_f32_16x16x32_bf16 v[84:87], a[124:127], v[160:163], v[84:87]
    v_mfma_f32_16x16x32_bf16 v[88:91], a[128:131], v[160:163], v[88:91]
    s_waitcnt vmcnt(10)
    s_barrier
    s_waitcnt lgkmcnt(0)
    v_mfma_f32_16x16x32_bf16 v[32:35], a[132:135], v[116:119], v[32:35]
    ds_read_b128 v[144:147], v7 offset:17920
    v_mfma_f32_16x16x32_bf16 v[36:39], a[136:139], v[116:119], v[36:39]
    v_mfma_f32_16x16x32_bf16 v[40:43], a[140:143], v[116:119], v[40:43]
    v_mfma_f32_16x16x32_bf16 v[44:47], a[132:135], v[120:123], v[44:47]
    v_mfma_f32_16x16x32_bf16 v[48:51], a[136:139], v[120:123], v[48:51]
    v_mfma_f32_16x16x32_bf16 v[52:55], a[140:143], v[120:123], v[52:55]
    v_mfma_f32_16x16x32_bf16 v[56:59], a[132:135], v[124:127], v[56:59]
    v_mfma_f32_16x16x32_bf16 v[60:63], a[136:139], v[124:127], v[60:63]
    v_mfma_f32_16x16x32_bf16 v[64:67], a[140:143], v[124:127], v[64:67]
    v_mfma_f32_16x16x32_bf16 v[68:71], a[132:135], v[128:131], v[68:71]
    v_mfma_f32_16x16x32_bf16 v[72:75], a[136:139], v[128:131], v[72:75]
    v_mfma_f32_16x16x32_bf16 v[76:79], a[140:143], v[128:131], v[76:79]
    v_mfma_f32_16x16x32_bf16 v[80:83], a[132:135], v[132:135], v[80:83]
    v_mfma_f32_16x16x32_bf16 v[84:87], a[136:139], v[132:135], v[84:87]
    v_mfma_f32_16x16x32_bf16 v[88:91], a[140:143], v[132:135], v[88:91]
    s_waitcnt lgkmcnt(0)
    v_mfma_f32_16x16x32_bf16 v[104:107], a[0:3], v[144:147], 0
    ds_read_b128 v[116:119], v7 offset:17984
    v_mfma_f32_16x16x32_bf16 v[108:111], a[4:7], v[144:147], 0
    v_mfma_f32_16x16x32_bf16 v[112:115], a[8:11], v[144:147], 0
    s_waitcnt lgkmcnt(0)
    v_mfma_f32_16x16x32_bf16 v[104:107], a[12:15], v[116:119], v[104:107]
    ds_read_b128 v[144:147], v7 offset:18048
    v_mfma_f32_16x16x32_bf16 v[108:111], a[16:19], v[116:119], v[108:111]
    v_mfma_f32_16x16x32_bf16 v[112:115], a[20:23], v[116:119], v[112:115]
    s_waitcnt lgkmcnt(0)
    v_mfma_f32_16x16x32_bf16 v[104:107], a[24:27], v[144:147], v[104:107]
    ds_read_b128 v[116:119], v7 offset:18368
    v_mfma_f32_16x16x32_bf16 v[108:111], a[28:31], v[144:147], v[108:111]
    v_mfma_f32_16x16x32_bf16 v[112:115], a[32:35], v[144:147], v[112:115]
    s_waitcnt lgkmcnt(0)
    v_mfma_f32_16x16x32_bf16 v[104:107], a[36:39], v[116:119], v[104:107]
    ds_read_b128 v[144:147], v7 offset:18432
    v_mfma_f32_16x16x32_bf16 v[108:111], a[40:43], v[116:119], v[108:111]
    v_mfma_f32_16x16x32_bf16 v[112:115], a[44:47], v[116:119], v[112:115]
    s_waitcnt lgkmcnt(0)
    v_mfma_f32_16x16x32_bf16 v[104:107], a[48:51], v[144:147], v[104:107]
    ds_read_b128 v[116:119], v7 offset:18496
    v_mfma_f32_16x16x32_bf16 v[108:111], a[52:55], v[144:147], v[108:111]
    v_mfma_f32_16x16x32_bf16 v[112:115], a[56:59], v[144:147], v[112:115]
    s_waitcnt lgkmcnt(0)
    v_mfma_f32_16x16x32_bf16 v[104:107], a[60:63], v[116:119], v[104:107]
    ds_read_b128 v[144:147], v7 offset:18816
    v_mfma_f32_16x16x32_bf16 v[108:111], a[64:67], v[116:119], v[108:111]
    v_mfma_f32_16x16x32_bf16 v[112:115], a[68:71], v[116:119], v[112:115]
    s_waitcnt lgkmcnt(0)
    v_mfma_f32_16x16x32_bf16 v[104:107], a[72:75], v[144:147], v[104:107]
    ds_read_b128 v[116:119], v7 offset:18880
    v_mfma_f32_16x16x32_bf16 v[108:111], a[76:79], v[144:147], v[108:111]
    v_mfma_f32_16x16x32_bf16 v[112:115], a[80:83], v[144:147], v[112:115]
    s_waitcnt lgkmcnt(0)
    v_mfma_f32_16x16x32_bf16 v[104:107], a[84:87], v[116:119], v[104:107]
    ds_read_b128 v[144:147], v7 offset:18944
    v_mfma_f32_16x16x32_bf16 v[108:111], a[88:91], v[116:119], v[108:111]
    v_mfma_f32_16x16x32_bf16 v[112:115], a[92:95], v[116:119], v[112:115]
    s_waitcnt lgkmcnt(0)
    v_mfma_f32_16x16x32_bf16 v[104:107], a[96:99], v[144:147], v[104:107]
    ds_read_b128 v[116:119], v7 offset:17920
    v_mfma_f32_16x16x32_bf16 v[108:111], a[100:103], v[144:147], v[108:111]
    ds_read_b128 v[120:123], v7 offset:26880
    v_mfma_f32_16x16x32_bf16 v[112:115], a[104:107], v[144:147], v[112:115]
    s_waitcnt lgkmcnt(0)
    v_mfma_f32_16x16x32_bf16 v[92:95], a[108:111], v[116:119], v[92:95]
    ds_read_b128 v[144:147], v7 offset:17984
    v_mfma_f32_16x16x32_bf16 v[96:99], a[112:115], v[116:119], v[96:99]
    ds_read_b128 v[148:151], v7 offset:26944
    v_mfma_f32_16x16x32_bf16 v[100:103], a[116:119], v[116:119], v[100:103]
    v_mfma_f32_16x16x32_bf16 v[104:107], a[108:111], v[120:123], v[104:107]
    v_mfma_f32_16x16x32_bf16 v[108:111], a[112:115], v[120:123], v[108:111]
    v_mfma_f32_16x16x32_bf16 v[112:115], a[116:119], v[120:123], v[112:115]
    s_waitcnt lgkmcnt(0)
    v_mfma_f32_16x16x32_bf16 v[92:95], a[120:123], v[144:147], v[92:95]
    ds_read_b128 v[116:119], v7 offset:18048
    v_mfma_f32_16x16x32_bf16 v[96:99], a[124:127], v[144:147], v[96:99]
    ds_read_b128 v[120:123], v7 offset:27008
    v_mfma_f32_16x16x32_bf16 v[100:103], a[128:131], v[144:147], v[100:103]
    v_mfma_f32_16x16x32_bf16 v[104:107], a[120:123], v[148:151], v[104:107]
    v_mfma_f32_16x16x32_bf16 v[108:111], a[124:127], v[148:151], v[108:111]
    v_mfma_f32_16x16x32_bf16 v[112:115], a[128:131], v[148:151], v[112:115]
    s_waitcnt vmcnt(26)
    s_barrier
    s_waitcnt lgkmcnt(0)
    v_mfma_f32_16x16x32_bf16 v[92:95], a[132:135], v[116:119], v[92:95]
    ds_read_b64_tr_b16 a[144:145], v8 offset:0
    v_mfma_f32_16x16x32_bf16 v[96:99], a[136:139], v[116:119], v[96:99]
    ds_read_b64_tr_b16 a[146:147], v8 offset:768
    v_mfma_f32_16x16x32_bf16 v[100:103], a[140:143], v[116:119], v[100:103]
    ds_read_b64_tr_b16 a[148:149], v8 offset:8
    v_mfma_f32_16x16x32_bf16 v[104:107], a[132:135], v[120:123], v[104:107]
    ds_read_b64_tr_b16 a[150:151], v8 offset:776
    s_add_u32 m0, s44, 144896
    s_add_u32 s26, s44, 129024
    buffer_load_dwordx4 v5, s[12:15], s26 offen lds
    v_mfma_f32_16x16x32_bf16 v[108:111], a[136:139], v[120:123], v[108:111]
    ds_read_b64_tr_b16 a[152:153], v9 offset:0
    v_mfma_f32_16x16x32_bf16 v[112:115], a[140:143], v[120:123], v[112:115]
    ds_read_b64_tr_b16 a[154:155], v9 offset:768
    ds_read_b128 v[144:147], v6 offset:9408
    ds_read_b128 v[148:151], v6 offset:18368
    ds_read_b128 v[152:155], v6 offset:27328
    ds_read_b128 v[156:159], v6 offset:36288
    ds_read_b128 v[160:163], v7 offset:9408
    ds_read_b128 v[164:167], v7 offset:18368
    ds_read_b128 v[168:171], v7 offset:27328
    s_waitcnt lgkmcnt(0)
    v_mfma_f32_16x16x32_bf16 v[32:35], a[144:147], v[144:147], v[32:35]
    ds_read_b64_tr_b16 a[156:157], v8 offset:6144
    v_mfma_f32_16x16x32_bf16 v[36:39], a[148:151], v[144:147], v[36:39]
    ds_read_b64_tr_b16 a[158:159], v8 offset:6912
    v_mfma_f32_16x16x32_bf16 v[40:43], a[152:155], v[144:147], v[40:43]
    ds_read_b64_tr_b16 a[160:161], v8 offset:6152
    s_add_u32 m0, s45, 144896
    s_add_u32 s26, s45, 129024
    buffer_load_dwordx4 v5, s[12:15], s26 offen lds
    v_mfma_f32_16x16x32_bf16 v[44:47], a[144:147], v[148:151], v[44:47]
    ds_read_b64_tr_b16 a[162:163], v8 offset:6920
    v_mfma_f32_16x16x32_bf16 v[48:51], a[148:151], v[148:151], v[48:51]
    ds_read_b64_tr_b16 a[164:165], v9 offset:6144
    v_mfma_f32_16x16x32_bf16 v[52:55], a[152:155], v[148:151], v[52:55]
    ds_read_b64_tr_b16 a[166:167], v9 offset:6912
    v_mfma_f32_16x16x32_bf16 v[56:59], a[144:147], v[152:155], v[56:59]
    ds_read_b128 v[116:119], v6 offset:9472
    v_mfma_f32_16x16x32_bf16 v[60:63], a[148:151], v[152:155], v[60:63]
    ds_read_b128 v[120:123], v6 offset:18432
    s_add_u32 m0, s46, 144896
    s_add_u32 s26, s46, 129024
    buffer_load_dwordx4 v5, s[12:15], s26 offen lds
    v_mfma_f32_16x16x32_bf16 v[64:67], a[152:155], v[152:155], v[64:67]
    ds_read_b128 v[124:127], v6 offset:27392
    v_mfma_f32_16x16x32_bf16 v[68:71], a[144:147], v[156:159], v[68:71]
    ds_read_b128 v[128:131], v6 offset:36352
    v_mfma_f32_16x16x32_bf16 v[72:75], a[148:151], v[156:159], v[72:75]
    ds_read_b128 v[132:135], v7 offset:9472
    v_mfma_f32_16x16x32_bf16 v[76:79], a[152:155], v[156:159], v[76:79]
    ds_read_b128 v[136:139], v7 offset:18432
    v_mfma_f32_16x16x32_bf16 v[80:83], a[144:147], v[160:163], v[80:83]
    ds_read_b128 v[140:143], v7 offset:27392
    s_add_u32 m0, s47, 144896
    s_add_u32 s26, s47, 129024
    buffer_load_dwordx4 v5, s[12:15], s26 offen lds
    v_mfma_f32_16x16x32_bf16 v[84:87], a[148:151], v[160:163], v[84:87]
    v_mfma_f32_16x16x32_bf16 v[88:91], a[152:155], v[160:163], v[88:91]
    v_mfma_f32_16x16x32_bf16 v[92:95], a[144:147], v[164:167], v[92:95]
    v_mfma_f32_16x16x32_bf16 v[96:99], a[148:151], v[164:167], v[96:99]
    v_mfma_f32_16x16x32_bf16 v[100:103], a[152:155], v[164:167], v[100:103]
    s_mov_b32 exec_hi, 0
    s_add_u32 m0, s48, 144896
    s_add_u32 s26, s48, 129024
    buffer_load_dwordx4 v5, s[12:15], s26 offen lds
    s_mov_b32 exec_hi, -1
    v_mfma_f32_16x16x32_bf16 v[104:107], a[144:147], v[168:171], v[104:107]
    v_mfma_f32_16x16x32_bf16 v[108:111], a[148:151], v[168:171], v[108:111]
    v_mfma_f32_16x16x32_bf16 v[112:115], a[152:155], v[168:171], v[112:115]
    s_waitcnt lgkmcnt(0)
    v_mfma_f32_16x16x32_bf16 v[32:35], a[156:159], v[116:119], v[32:35]
    ds_read_b64_tr_b16 a[168:169], v8 offset:12288
    v_mfma_f32_16x16x32_bf16 v[36:39], a[160:163], v[116:119], v[36:39]
    ds_read_b64_tr_b16 a[170:171], v8 offset:13056
    v_mfma_f32_16x16x32_bf16 v[40:43], a[164:167], v[116:119], v[40:43]
    ds_read_b64_tr_b16 a[172:173], v8 offset:12296
    v_mfma_f32_16x16x32_bf16 v[44:47], a[156:159], v[120:123], v[44:47]
    ds_read_b64_tr_b16 a[174:175], v8 offset:13064
    v_mfma_f32_16x16x32_bf16 v[48:51], a[160:163], v[120:123], v[48:51]
    ds_read_b64_tr_b16 a[176:177], v9 offset:12288
    v_mfma_f32_16x16x32_bf16 v[52:55], a[164:167], v[120:123], v[52:55]
    ds_read_b64_tr_b16 a[178:179], v9 offset:13056
    v_mfma_f32_16x16x32_bf16 v[56:59], a[156:159], v[124:127], v[56:59]
    ds_read_b128 v[144:147], v6 offset:9536
    v_mfma_f32_16x16x32_bf16 v[60:63], a[160:163], v[124:127], v[60:63]
    ds_read_b128 v[148:151], v6 offset:18496
    v_mfma_f32_16x16x32_bf16 v[64:67], a[164:167], v[124:127], v[64:67]
    ds_read_b128 v[152:155], v6 offset:27456
    v_mfma_f32_16x16x32_bf16 v[68:71], a[156:159], v[128:131], v[68:71]
    ds_read_b128 v[156:159], v6 offset:36416
    v_mfma_f32_16x16x32_bf16 v[72:75], a[160:163], v[128:131], v[72:75]
    ds_read_b128 v[160:163], v7 offset:9536
    v_mfma_f32_16x16x32_bf16 v[76:79], a[164:167], v[128:131], v[76:79]
    ds_read_b128 v[164:167], v7 offset:18496
    v_mfma_f32_16x16x32_bf16 v[80:83], a[156:159], v[132:135], v[80:83]
    ds_read_b128 v[168:171], v7 offset:27456
    v_mfma_f32_16x16x32_bf16 v[84:87], a[160:163], v[132:135], v[84:87]
    v_mfma_f32_16x16x32_bf16 v[88:91], a[164:167], v[132:135], v[88:91]
    v_mfma_f32_16x16x32_bf16 v[92:95], a[156:159], v[136:139], v[92:95]
    v_mfma_f32_16x16x32_bf16 v[96:99], a[160:163], v[136:139], v[96:99]
    v_mfma_f32_16x16x32_bf16 v[100:103], a[164:167], v[136:139], v[100:103]
    v_mfma_f32_16x16x32_bf16 v[104:107], a[156:159], v[140:143], v[104:107]
    v_mfma_f32_16x16x32_bf16 v[108:111], a[160:163], v[140:143], v[108:111]
    v_mfma_f32_16x16x32_bf16 v[112:115], a[164:167], v[140:143], v[112:115]
    s_waitcnt vmcnt(20)
    s_barrier
    s_waitcnt lgkmcnt(0)
    v_mfma_f32_16x16x32_bf16 v[32:35], a[168:171], v[144:147], v[32:35]
    ds_read_b64_tr_b16 a[180:181], v8 offset:18432
    v_mfma_f32_16x16x32_bf16 v[36:39], a[172:175], v[144:147], v[36:39]
    ds_read_b64_tr_b16 a[182:183], v8 offset:19200
    v_mfma_f32_16x16x32_bf16 v[40:43], a[176:179], v[144:147], v[40:43]
    ds_read_b64_tr_b16 a[184:185], v8 offset:18440
    v_mfma_f32_16x16x32_bf16 v[44:47], a[168:171], v[148:151], v[44:47]
    ds_read_b64_tr_b16 a[186:187], v8 offset:19208
    v_mfma_f32_16x16x32_bf16 v[48:51], a[172:175], v[148:151], v[48:51]
    ds_read_b64_tr_b16 a[188:189], v9 offset:18432
    v_mfma_f32_16x16x32_bf16 v[52:55], a[176:179], v[148:151], v[52:55]
    ds_read_b64_tr_b16 a[190:191], v9 offset:19200
    v_mfma_f32_16x16x32_bf16 v[56:59], a[168:171], v[152:155], v[56:59]
    ds_read_b128 v[116:119], v6 offset:9856
    v_mfma_f32_16x16x32_bf16 v[60:63], a[172:175], v[152:155], v[60:63]
    ds_read_b128 v[120:123], v6 offset:18816
    v_mfma_f32_16x16x32_bf16 v[64:67], a[176:179], v[152:155], v[64:67]
    ds_read_b128 v[124:127], v6 offset:27776
    v_mfma_f32_16x16x32_bf16 v[68:71], a[168:171], v[156:159], v[68:71]
    ds_read_b128 v[128:131], v6 offset:36736
    v_mfma_f32_16x16x32_bf16 v[72:75], a[172:175], v[156:159], v[72:75]
    ds_read_b128 v[132:135], v7 offset:9856
    v_mfma_f32_16x16x32_bf16 v[76:79], a[176:179], v[156:159], v[76:79]
    ds_read_b128 v[136:139], v7 offset:18816
    v_mfma_f32_16x16x32_bf16 v[80:83], a[168:171], v[160:163], v[80:83]
    ds_read_b128 v[140:143], v7 offset:27776
    v_mfma_f32_16x16x32_bf16 v[84:87], a[172:175], v[160:163], v[84:87]
    v_mfma_f32_16x16x32_bf16 v[88:91], a[176:179], v[160:163], v[88:91]
    v_mfma_f32_16x16x32_bf16 v[92:95], a[168:171], v[164:167], v[92:95]
    v_mfma_f32_16x16x32_bf16 v[96:99], a[172:175], v[164:167], v[96:99]
    v_mfma_f32_16x16x32_bf16 v[100:103], a[176:179], v[164:167], v[100:103]
    v_mfma_f32_16x16x32_bf16 v[104:107], a[168:171], v[168:171], v[104:107]
    v_mfma_f32_16x16x32_bf16 v[108:111], a[172:175], v[168:171], v[108:111]
    v_mfma_f32_16x16x32_bf16 v[112:115], a[176:179], v[168:171], v[112:115]
    s_waitcnt lgkmcnt(0)
    v_mfma_f32_16x16x32_bf16 v[32:35], a[180:183], v[116:119], v[32:35]
    ds_read_b64_tr_b16 a[192:193], v8 offset:24576
    v_mfma_f32_16x16x32_bf16 v[36:39], a[184:187], v[116:119], v[36:39]
    ds_read_b64_tr_b16 a[194:195], v8 offset:25344
    v_mfma_f32_16x16x32_bf16 v[40:43], a[188:191], v[116:119], v[40:43]
    ds_read_b64_tr_b16 a[196:197], v8 offset:24584
    v_mfma_f32_16x16x32_bf16 v[44:47], a[180:183], v[120:123], v[44:47]
    ds_read_b64_tr_b16 a[198:199], v8 offset:25352
    v_mfma_f32_16x16x32_bf16 v[48:51], a[184:187], v[120:123], v[48:51]
    ds_read_b64_tr_b16 a[200:201], v9 offset:24576
    v_mfma_f32_16x16x32_bf16 v[52:55], a[188:191], v[120:123], v[52:55]
    ds_read_b64_tr_b16 a[202:203], v9 offset:25344
    v_mfma_f32_16x16x32_bf16 v[56:59], a[180:183], v[124:127], v[56:59]
    ds_read_b128 v[144:147], v6 offset:9920
    v_mfma_f32_16x16x32_bf16 v[60:63], a[184:187], v[124:127], v[60:63]
    ds_read_b128 v[148:151], v6 offset:18880
    v_mfma_f32_16x16x32_bf16 v[64:67], a[188:191], v[124:127], v[64:67]
    ds_read_b128 v[152:155], v6 offset:27840
    v_mfma_f32_16x16x32_bf16 v[68:71], a[180:183], v[128:131], v[68:71]
    ds_read_b128 v[156:159], v6 offset:36800
    v_mfma_f32_16x16x32_bf16 v[72:75], a[184:187], v[128:131], v[72:75]
    ds_read_b128 v[160:163], v7 offset:9920
    v_mfma_f32_16x16x32_bf16 v[76:79], a[188:191], v[128:131], v[76:79]
    ds_read_b128 v[164:167], v7 offset:18880
    v_mfma_f32_16x16x32_bf16 v[80:83], a[180:183], v[132:135], v[80:83]
    ds_read_b128 v[168:171], v7 offset:27840
    v_mfma_f32_16x16x32_bf16 v[84:87], a[184:187], v[132:135], v[84:87]
    v_mfma_f32_16x16x32_bf16 v[88:91], a[188:191], v[132:135], v[88:91]
    v_mfma_f32_16x16x32_bf16 v[92:95], a[180:183], v[136:139], v[92:95]
    v_mfma_f32_16x16x32_bf16 v[96:99], a[184:187], v[136:139], v[96:99]
    v_mfma_f32_16x16x32_bf16 v[100:103], a[188:191], v[136:139], v[100:103]
    v_mfma_f32_16x16x32_bf16 v[104:107], a[180:183], v[140:143], v[104:107]
    v_mfma_f32_16x16x32_bf16 v[108:111], a[184:187], v[140:143], v[108:111]
    v_mfma_f32_16x16x32_bf16 v[112:115], a[188:191], v[140:143], v[112:115]
    s_waitcnt lgkmcnt(0)
    v_mfma_f32_16x16x32_bf16 v[32:35], a[192:195], v[144:147], v[32:35]
    ds_read_b64_tr_b16 a[204:205], v8 offset:30720
    v_mfma_f32_16x16x32_bf16 v[36:39], a[196:199], v[144:147], v[36:39]
    ds_read_b64_tr_b16 a[206:207], v8 offset:31488
    v_mfma_f32_16x16x32_bf16 v[40:43], a[200:203], v[144:147], v[40:43]
    ds_read_b64_tr_b16 a[208:209], v8 offset:30728
    v_mfma_f32_16x16x32_bf16 v[44:47], a[192:195], v[148:151], v[44:47]
    ds_read_b64_tr_b16 a[210:211], v8 offset:31496
    v_mfma_f32_16x16x32_bf16 v[48:51], a[196:199], v[148:151], v[48:51]
    ds_read_b64_tr_b16 a[212:213], v9 offset:30720
    v_mfma_f32_16x16x32_bf16 v[52:55], a[200:203], v[148:151], v[52:55]
    ds_read_b64_tr_b16 a[214:215], v9 offset:31488
    v_mfma_f32_16x16x32_bf16 v[56:59], a[192:195], v[152:155], v[56:59]
    ds_read_b128 v[116:119], v6 offset:9984
    v_mfma_f32_16x16x32_bf16 v[60:63], a[196:199], v[152:155], v[60:63]
    ds_read_b128 v[120:123], v6 offset:18944
    v_mfma_f32_16x16x32_bf16 v[64:67], a[200:203], v[152:155], v[64:67]
    ds_read_b128 v[124:127], v6 offset:27904
    v_mfma_f32_16x16x32_bf16 v[68:71], a[192:195], v[156:159], v[68:71]
    ds_read_b128 v[128:131], v6 offset:36864
    v_mfma_f32_16x16x32_bf16 v[72:75], a[196:199], v[156:159], v[72:75]
    ds_read_b128 v[132:135], v7 offset:9984
    v_mfma_f32_16x16x32_bf16 v[76:79], a[200:203], v[156:159], v[76:79]
    ds_read_b128 v[136:139], v7 offset:18944
    v_mfma_f32_16x16x32_bf16 v[80:83], a[192:195], v[160:163], v[80:83]
    ds_read_b128 v[140:143], v7 offset:27904
    v_mfma_f32_16x16x32_bf16 v[84:87], a[196:199], v[160:163], v[84:87]
    v_mfma_f32_16x16x32_bf16 v[88:91], a[200:203], v[160:163], v[88:91]
    v_mfma_f32_16x16x32_bf16 v[92:95], a[192:195], v[164:167], v[92:95]
    v_mfma_f32_16x16x32_bf16 v[96:99], a[196:199], v[164:167], v[96:99]
    v_mfma_f32_16x16x32_bf16 v[100:103], a[200:203], v[164:167], v[100:103]
    v_mfma_f32_16x16x32_bf16 v[104:107], a[192:195], v[168:171], v[104:107]
    v_mfma_f32_16x16x32_bf16 v[108:111], a[196:199], v[168:171], v[108:111]
    v_mfma_f32_16x16x32_bf16 v[112:115], a[200:203], v[168:171], v[112:115]
    s_waitcnt vmcnt(5)
    s_barrier
    s_waitcnt lgkmcnt(0)
    v_mfma_f32_16x16x32_bf16 v[32:35], a[204:207], v[116:119], v[32:35]
    ds_read_b64_tr_b16 a[216:217], v10 offset:0
    v_mfma_f32_16x16x32_bf16 v[36:39], a[208:211], v[116:119], v[36:39]
    ds_read_b64_tr_b16 a[218:219], v10 offset:768
    v_mfma_f32_16x16x32_bf16 v[40:43], a[212:215], v[116:119], v[40:43]
    ds_read_b64_tr_b16 a[220:221], v10 offset:8
    s_add_u32 m0, s44, 89600
    s_add_u32 s26, s44, 147456
    buffer_load_dwordx4 v5, s[12:15], s26 offen lds
    v_mfma_f32_16x16x32_bf16 v[44:47], a[204:207], v[120:123], v[44:47]
    ds_read_b64_tr_b16 a[222:223], v10 offset:776
    v_mfma_f32_16x16x32_bf16 v[48:51], a[208:211], v[120:123], v[48:51]
    ds_read_b64_tr_b16 a[224:225], v11 offset:0
    v_mfma_f32_16x16x32_bf16 v[52:55], a[212:215], v[120:123], v[52:55]
    ds_read_b64_tr_b16 a[226:227], v11 offset:768
    v_mfma_f32_16x16x32_bf16 v[56:59], a[204:207], v[124:127], v[56:59]
    ds_read_b128 v[144:147], v6 offset:17920
    v_mfma_f32_16x16x32_bf16 v[60:63], a[208:211], v[124:127], v[60:63]
    ds_read_b128 v[148:151], v6 offset:26880
    s_add_u32 m0, s45, 89600
    s_add_u32 s26, s45, 147456
    buffer_load_dwordx4 v5, s[12:15], s26 offen lds
    v_mfma_f32_16x16x32_bf16 v[64:67], a[212:215], v[124:127], v[64:67]
    ds_read_b128 v[152:155], v6 offset:35840
    v_mfma_f32_16x16x32_bf16 v[68:71], a[204:207], v[128:131], v[68:71]
    ds_read_b128 v[156:159], v6 offset:44800
    v_mfma_f32_16x16x32_bf16 v[72:75], a[208:211], v[128:131], v[72:75]
    ds_read_b128 v[160:163], v7 offset:17920
    v_mfma_f32_16x16x32_bf16 v[76:79], a[212:215], v[128:131], v[76:79]
    ds_read_b128 v[164:167], v7 offset:26880
    v_mfma_f32_16x16x32_bf16 v[80:83], a[204:207], v[132:135], v[80:83]
    ds_read_b128 v[168:171], v7 offset:35840
    s_add_u32 m0, s46, 89600
    s_add_u32 s26, s46, 147456
    buffer_load_dwordx4 v5, s[12:15], s26 offen lds
    v_mfma_f32_16x16x32_bf16 v[84:87], a[208:211], v[132:135], v[84:87]
    v_mfma_f32_16x16x32_bf16 v[88:91], a[212:215], v[132:135], v[88:91]
    v_mfma_f32_16x16x32_bf16 v[92:95], a[204:207], v[136:139], v[92:95]
    v_mfma_f32_16x16x32_bf16 v[96:99], a[208:211], v[136:139], v[96:99]
    v_mfma_f32_16x16x32_bf16 v[100:103], a[212:215], v[136:139], v[100:103]
    s_add_u32 m0, s47, 89600
    s_add_u32 s26, s47, 147456
    buffer_load_dwordx4 v5, s[12:15], s26 offen lds
    v_mfma_f32_16x16x32_bf16 v[104:107], a[204:207], v[140:143], v[104:107]
    v_mfma_f32_16x16x32_bf16 v[108:111], a[208:211], v[140:143], v[108:111]
    v_mfma_f32_16x16x32_bf16 v[112:115], a[212:215], v[140:143], v[112:115]
    s_waitcnt lgkmcnt(0)
    v_mfma_f32_16x16x32_bf16 v[32:35], a[216:219], v[144:147], v[32:35]
    ds_read_b64_tr_b16 a[228:229], v10 offset:6144
    v_mfma_f32_16x16x32_bf16 v[36:39], a[220:223], v[144:147], v[36:39]
    ds_read_b64_tr_b16 a[230:231], v10 offset:6912
    s_mov_b32 exec_hi, 0
    s_add_u32 m0, s48, 89600
    s_add_u32 s26, s48, 147456
    buffer_load_dwordx4 v5, s[12:15], s26 offen lds
    s_mov_b32 exec_hi, -1
    v_mfma_f32_16x16x32_bf16 v[40:43], a[224:227], v[144:147], v[40:43]
    ds_read_b64_tr_b16 a[232:233], v10 offset:6152
    v_mfma_f32_16x16x32_bf16 v[44:47], a[216:219], v[148:151], v[44:47]
    ds_read_b64_tr_b16 a[234:235], v10 offset:6920
    v_mfma_f32_16x16x32_bf16 v[48:51], a[220:223], v[148:151], v[48:51]
    ds_read_b64_tr_b16 a[236:237], v11 offset:6144
    v_mfma_f32_16x16x32_bf16 v[52:55], a[224:227], v[148:151], v[52:55]
    ds_read_b64_tr_b16 a[238:239], v11 offset:6912
    v_mfma_f32_16x16x32_bf16 v[56:59], a[216:219], v[152:155], v[56:59]
    ds_read_b128 v[116:119], v6 offset:17984
    v_mfma_f32_16x16x32_bf16 v[60:63], a[220:223], v[152:155], v[60:63]
    ds_read_b128 v[120:123], v6 offset:26944
    v_mfma_f32_16x16x32_bf16 v[64:67], a[224:227], v[152:155], v[64:67]
    ds_read_b128 v[124:127], v6 offset:35904
    v_mfma_f32_16x16x32_bf16 v[68:71], a[216:219], v[156:159], v[68:71]
    ds_read_b128 v[128:131], v6 offset:44864
    v_mfma_f32_16x16x32_bf16 v[72:75], a[220:223], v[156:159], v[72:75]
    ds_read_b128 v[132:135], v7 offset:17984
    v_mfma_f32_16x16x32_bf16 v[76:79], a[224:227], v[156:159], v[76:79]
    ds_read_b128 v[136:139], v7 offset:26944
    v_mfma_f32_16x16x32_bf16 v[80:83], a[216:219], v[160:163], v[80:83]
    ds_read_b128 v[140:143], v7 offset:35904
    v_mfma_f32_16x16x32_bf16 v[84:87], a[220:223], v[160:163], v[84:87]
    v_mfma_f32_16x16x32_bf16 v[88:91], a[224:227], v[160:163], v[88:91]
    v_mfma_f32_16x16x32_bf16 v[92:95], a[216:219], v[164:167], v[92:95]
    v_mfma_f32_16x16x32_bf16 v[96:99], a[220:223], v[164:167], v[96:99]
    v_mfma_f32_16x16x32_bf16 v[100:103], a[224:227], v[164:167], v[100:103]
    v_mfma_f32_16x16x32_bf16 v[104:107], a[216:219], v[168:171], v[104:107]
    v_mfma_f32_16x16x32_bf16 v[108:111], a[220:223], v[168:171], v[108:111]
    v_mfma_f32_16x16x32_bf16 v[112:115], a[224:227], v[168:171], v[112:115]
    s_waitcnt lgkmcnt(0)
    v_mfma_f32_16x16x32_bf16 v[32:35], a[228:231], v[116:119], v[32:35]
    ds_read_b64_tr_b16 a[240:241], v10 offset:12288
    v_mfma_f32_16x16x32_bf16 v[36:39], a[232:235], v[116:119], v[36:39]
    ds_read_b64_tr_b16 a[242:243], v10 offset:13056
    v_mfma_f32_16x16x32_bf16 v[40:43], a[236:239], v[116:119], v[40:43]
    ds_read_b64_tr_b16 a[244:245], v10 offset:12296
    v_mfma_f32_16x16x32_bf16 v[44:47], a[228:231], v[120:123], v[44:47]
    ds_read_b64_tr_b16 a[246:247], v10 offset:13064
    v_mfma_f32_16x16x32_bf16 v[48:51], a[232:235], v[120:123], v[48:51]
    ds_read_b64_tr_b16 a[248:249], v11 offset:12288
    v_mfma_f32_16x16x32_bf16 v[52:55], a[236:239], v[120:123], v[52:55]
    ds_read_b64_tr_b16 a[250:251], v11 offset:13056
    v_mfma_f32_16x16x32_bf16 v[56:59], a[228:231], v[124:127], v[56:59]
    ds_read_b128 v[144:147], v6 offset:18048
    v_mfma_f32_16x16x32_bf16 v[60:63], a[232:235], v[124:127], v[60:63]
    ds_read_b128 v[148:151], v6 offset:27008
    v_mfma_f32_16x16x32_bf16 v[64:67], a[236:239], v[124:127], v[64:67]
    ds_read_b128 v[152:155], v6 offset:35968
    v_mfma_f32_16x16x32_bf16 v[68:71], a[228:231], v[128:131], v[68:71]
    ds_read_b128 v[156:159], v6 offset:44928
    v_mfma_f32_16x16x32_bf16 v[72:75], a[232:235], v[128:131], v[72:75]
    ds_read_b128 v[160:163], v7 offset:18048
    v_mfma_f32_16x16x32_bf16 v[76:79], a[236:239], v[128:131], v[76:79]
    ds_read_b128 v[164:167], v7 offset:27008
    v_mfma_f32_16x16x32_bf16 v[80:83], a[228:231], v[132:135], v[80:83]
    ds_read_b128 v[168:171], v7 offset:35968
    v_mfma_f32_16x16x32_bf16 v[84:87], a[232:235], v[132:135], v[84:87]
    v_mfma_f32_16x16x32_bf16 v[88:91], a[236:239], v[132:135], v[88:91]
    v_mfma_f32_16x16x32_bf16 v[92:95], a[228:231], v[136:139], v[92:95]
    v_mfma_f32_16x16x32_bf16 v[96:99], a[232:235], v[136:139], v[96:99]
    v_mfma_f32_16x16x32_bf16 v[100:103], a[236:239], v[136:139], v[100:103]
    v_mfma_f32_16x16x32_bf16 v[104:107], a[228:231], v[140:143], v[104:107]
    v_mfma_f32_16x16x32_bf16 v[108:111], a[232:235], v[140:143], v[108:111]
    v_mfma_f32_16x16x32_bf16 v[112:115], a[236:239], v[140:143], v[112:115]
    s_waitcnt vmcnt(5)
    s_barrier
    s_waitcnt lgkmcnt(0)
    v_mfma_f32_16x16x32_bf16 v[32:35], a[240:243], v[144:147], v[32:35]
    ds_read_b64_tr_b16 v[184:185], v10 offset:18432
    v_mfma_f32_16x16x32_bf16 v[36:39], a[244:247], v[144:147], v[36:39]
    ds_read_b64_tr_b16 v[186:187], v10 offset:19200
    v_mfma_f32_16x16x32_bf16 v[40:43], a[248:251], v[144:147], v[40:43]
    ds_read_b64_tr_b16 v[188:189], v10 offset:18440
    v_mfma_f32_16x16x32_bf16 v[44:47], a[240:243], v[148:151], v[44:47]
    ds_read_b64_tr_b16 v[190:191], v10 offset:19208
    v_mfma_f32_16x16x32_bf16 v[48:51], a[244:247], v[148:151], v[48:51]
    ds_read_b64_tr_b16 v[192:193], v11 offset:18432
    v_mfma_f32_16x16x32_bf16 v[52:55], a[248:251], v[148:151], v[52:55]
    ds_read_b64_tr_b16 v[194:195], v11 offset:19200
    v_mfma_f32_16x16x32_bf16 v[56:59], a[240:243], v[152:155], v[56:59]
    ds_read_b128 v[116:119], v6 offset:18368
    v_mfma_f32_16x16x32_bf16 v[60:63], a[244:247], v[152:155], v[60:63]
    ds_read_b128 v[120:123], v6 offset:27328
    v_mfma_f32_16x16x32_bf16 v[64:67], a[248:251], v[152:155], v[64:67]
    ds_read_b128 v[124:127], v6 offset:36288
    v_mfma_f32_16x16x32_bf16 v[68:71], a[240:243], v[156:159], v[68:71]
    v_mfma_f32_16x16x32_bf16 v[72:75], a[244:247], v[156:159], v[72:75]
    v_mfma_f32_16x16x32_bf16 v[76:79], a[248:251], v[156:159], v[76:79]
    v_mfma_f32_16x16x32_bf16 v[80:83], a[240:243], v[160:163], v[80:83]
    v_mfma_f32_16x16x32_bf16 v[84:87], a[244:247], v[160:163], v[84:87]
    v_mfma_f32_16x16x32_bf16 v[88:91], a[248:251], v[160:163], v[88:91]
    v_mfma_f32_16x16x32_bf16 v[92:95], a[240:243], v[164:167], v[92:95]
    v_mfma_f32_16x16x32_bf16 v[96:99], a[244:247], v[164:167], v[96:99]
    v_mfma_f32_16x16x32_bf16 v[100:103], a[248:251], v[164:167], v[100:103]
    v_mfma_f32_16x16x32_bf16 v[104:107], a[240:243], v[168:171], v[104:107]
    v_mfma_f32_16x16x32_bf16 v[108:111], a[244:247], v[168:171], v[108:111]
    v_mfma_f32_16x16x32_bf16 v[112:115], a[248:251], v[168:171], v[112:115]
    s_waitcnt lgkmcnt(0)
    v_mfma_f32_16x16x32_bf16 v[32:35], v[184:187], v[116:119], v[32:35]
    ds_read_b64_tr_b16 v[196:197], v10 offset:24576
    v_mfma_f32_16x16x32_bf16 v[36:39], v[188:191], v[116:119], v[36:39]
    ds_read_b64_tr_b16 v[198:199], v10 offset:25344
    v_mfma_f32_16x16x32_bf16 v[40:43], v[192:195], v[116:119], v[40:43]
    ds_read_b64_tr_b16 v[200:201], v10 offset:24584
    v_mfma_f32_16x16x32_bf16 v[44:47], v[184:187], v[120:123], v[44:47]
    ds_read_b64_tr_b16 v[202:203], v10 offset:25352
    v_mfma_f32_16x16x32_bf16 v[48:51], v[188:191], v[120:123], v[48:51]
    ds_read_b64_tr_b16 v[204:205], v11 offset:24576
    v_mfma_f32_16x16x32_bf16 v[52:55], v[192:195], v[120:123], v[52:55]
    ds_read_b64_tr_b16 v[206:207], v11 offset:25344
    v_mfma_f32_16x16x32_bf16 v[56:59], v[184:187], v[124:127], v[56:59]
    ds_read_b128 v[144:147], v6 offset:18432
    v_mfma_f32_16x16x32_bf16 v[60:63], v[188:191], v[124:127], v[60:63]
    ds_read_b128 v[148:151], v6 offset:27392
    v_mfma_f32_16x16x32_bf16 v[64:67], v[192:195], v[124:127], v[64:67]
    ds_read_b128 v[152:155], v6 offset:36352
    s_waitcnt lgkmcnt(0)
    v_mfma_f32_16x16x32_bf16 v[32:35], v[196:199], v[144:147], v[32:35]
    ds_read_b64_tr_b16 v[208:209], v10 offset:30720
    v_mfma_f32_16x16x32_bf16 v[36:39], v[200:203], v[144:147], v[36:39]
    ds_read_b64_tr_b16 v[210:211], v10 offset:31488
    v_mfma_f32_16x16x32_bf16 v[40:43], v[204:207], v[144:147], v[40:43]
    ds_read_b64_tr_b16 v[212:213], v10 offset:30728
    v_mfma_f32_16x16x32_bf16 v[44:47], v[196:199], v[148:151], v[44:47]
    ds_read_b64_tr_b16 v[214:215], v10 offset:31496
    v_mfma_f32_16x16x32_bf16 v[48:51], v[200:203], v[148:151], v[48:51]
    ds_read_b64_tr_b16 v[216:217], v11 offset:30720
    v_mfma_f32_16x16x32_bf16 v[52:55], v[204:207], v[148:151], v[52:55]
    ds_read_b64_tr_b16 v[218:219], v11 offset:31488
    v_mfma_f32_16x16x32_bf16 v[56:59], v[196:199], v[152:155], v[56:59]
    ds_read_b128 v[116:119], v6 offset:18496
    v_mfma_f32_16x16x32_bf16 v[60:63], v[200:203], v[152:155], v[60:63]
    ds_read_b128 v[120:123], v6 offset:27456
    v_mfma_f32_16x16x32_bf16 v[64:67], v[204:207], v[152:155], v[64:67]
    ds_read_b128 v[124:127], v6 offset:36416
    s_waitcnt vmcnt(0)
    s_barrier
    s_waitcnt lgkmcnt(0)
    v_mfma_f32_16x16x32_bf16 v[32:35], v[208:211], v[116:119], v[32:35]
    ds_read_b64_tr_b16 v[220:221], v8 offset:0
    v_mfma_f32_16x16x32_bf16 v[36:39], v[212:215], v[116:119], v[36:39]
    ds_read_b64_tr_b16 v[222:223], v8 offset:768
    v_mfma_f32_16x16x32_bf16 v[40:43], v[216:219], v[116:119], v[40:43]
    ds_read_b64_tr_b16 v[224:225], v8 offset:8
    v_mfma_f32_16x16x32_bf16 v[44:47], v[208:211], v[120:123], v[44:47]
    ds_read_b64_tr_b16 v[226:227], v8 offset:776
    v_mfma_f32_16x16x32_bf16 v[48:51], v[212:215], v[120:123], v[48:51]
    ds_read_b64_tr_b16 v[228:229], v9 offset:0
    v_mfma_f32_16x16x32_bf16 v[52:55], v[216:219], v[120:123], v[52:55]
    ds_read_b64_tr_b16 v[230:231], v9 offset:768
    v_mfma_f32_16x16x32_bf16 v[56:59], v[208:211], v[124:127], v[56:59]
    ds_read_b128 v[144:147], v6 offset:18816
    v_mfma_f32_16x16x32_bf16 v[60:63], v[212:215], v[124:127], v[60:63]
    ds_read_b128 v[148:151], v6 offset:27776
    v_mfma_f32_16x16x32_bf16 v[64:67], v[216:219], v[124:127], v[64:67]
    ds_read_b128 v[152:155], v6 offset:36736
    s_waitcnt lgkmcnt(0)
    v_mfma_f32_16x16x32_bf16 v[32:35], v[220:223], v[144:147], v[32:35]
    ds_read_b64_tr_b16 v[232:233], v8 offset:6144
    v_mfma_f32_16x16x32_bf16 v[36:39], v[224:227], v[144:147], v[36:39]
    ds_read_b64_tr_b16 v[234:235], v8 offset:6912
    v_mfma_f32_16x16x32_bf16 v[40:43], v[228:231], v[144:147], v[40:43]
    ds_read_b64_tr_b16 v[236:237], v8 offset:6152
    v_mfma_f32_16x16x32_bf16 v[44:47], v[220:223], v[148:151], v[44:47]
    ds_read_b64_tr_b16 v[238:239], v8 offset:6920
    v_mfma_f32_16x16x32_bf16 v[48:51], v[224:227], v[148:151], v[48:51]
    ds_read_b64_tr_b16 v[240:241], v9 offset:6144
    v_mfma_f32_16x16x32_bf16 v[52:55], v[228:231], v[148:151], v[52:55]
    ds_read_b64_tr_b16 v[242:243], v9 offset:6912
    v_mfma_f32_16x16x32_bf16 v[56:59], v[220:223], v[152:155], v[56:59]
    ds_read_b128 v[116:119], v6 offset:18880
    v_mfma_f32_16x16x32_bf16 v[60:63], v[224:227], v[152:155], v[60:63]
    ds_read_b128 v[120:123], v6 offset:27840
    v_mfma_f32_16x16x32_bf16 v[64:67], v[228:231], v[152:155], v[64:67]
    ds_read_b128 v[124:127], v6 offset:36800
    s_waitcnt lgkmcnt(0)
    v_mfma_f32_16x16x32_bf16 v[32:35], v[232:235], v[116:119], v[32:35]
    ds_read_b64_tr_b16 v[244:245], v8 offset:12288
    v_mfma_f32_16x16x32_bf16 v[36:39], v[236:239], v[116:119], v[36:39]
    ds_read_b64_tr_b16 v[246:247], v8 offset:13056
    v_mfma_f32_16x16x32_bf16 v[40:43], v[240:243], v[116:119], v[40:43]
    ds_read_b64_tr_b16 v[248:249], v8 offset:12296
    v_mfma_f32_16x16x32_bf16 v[44:47], v[232:235], v[120:123], v[44:47]
    ds_read_b64_tr_b16 v[250:251], v8 offset:13064
    v_mfma_f32_16x16x32_bf16 v[48:51], v[236:239], v[120:123], v[48:51]
    ds_read_b64_tr_b16 v[252:253], v9 offset:12288
    v_mfma_f32_16x16x32_bf16 v[52:55], v[240:243], v[120:123], v[52:55]
    ds_read_b64_tr_b16 v[254:255], v9 offset:13056
    v_mfma_f32_16x16x32_bf16 v[56:59], v[232:235], v[124:127], v[56:59]
    ds_read_b128 v[144:147], v6 offset:18944
    v_mfma_f32_16x16x32_bf16 v[60:63], v[236:239], v[124:127], v[60:63]
    ds_read_b128 v[148:151], v6 offset:27904
    v_mfma_f32_16x16x32_bf16 v[64:67], v[240:243], v[124:127], v[64:67]
    ds_read_b128 v[152:155], v6 offset:36864
    s_waitcnt lgkmcnt(0)
    v_mfma_f32_16x16x32_bf16 v[32:35], v[244:247], v[144:147], v[32:35]
    ds_read_b128 v[116:119], v6 offset:45248
    v_mfma_f32_16x16x32_bf16 v[36:39], v[248:251], v[144:147], v[36:39]
    ds_read_b128 v[120:123], v7 offset:18368
    v_mfma_f32_16x16x32_bf16 v[40:43], v[252:255], v[144:147], v[40:43]
    v_mfma_f32_16x16x32_bf16 v[44:47], v[244:247], v[148:151], v[44:47]
    v_mfma_f32_16x16x32_bf16 v[48:51], v[248:251], v[148:151], v[48:51]
    v_mfma_f32_16x16x32_bf16 v[52:55], v[252:255], v[148:151], v[52:55]
    v_mfma_f32_16x16x32_bf16 v[56:59], v[244:247], v[152:155], v[56:59]
    v_mfma_f32_16x16x32_bf16 v[60:63], v[248:251], v[152:155], v[60:63]
    v_mfma_f32_16x16x32_bf16 v[64:67], v[252:255], v[152:155], v[64:67]
    s_waitcnt lgkmcnt(0)
    v_mfma_f32_16x16x32_bf16 v[68:71], v[184:187], v[116:119], v[68:71]
    ds_read_b128 v[144:147], v6 offset:45312
    v_mfma_f32_16x16x32_bf16 v[72:75], v[188:191], v[116:119], v[72:75]
    ds_read_b128 v[148:151], v7 offset:18432
    v_mfma_f32_16x16x32_bf16 v[76:79], v[192:195], v[116:119], v[76:79]
    v_mfma_f32_16x16x32_bf16 v[80:83], v[184:187], v[120:123], v[80:83]
    v_mfma_f32_16x16x32_bf16 v[84:87], v[188:191], v[120:123], v[84:87]
    v_mfma_f32_16x16x32_bf16 v[88:91], v[192:195], v[120:123], v[88:91]
    s_waitcnt lgkmcnt(0)
    v_mfma_f32_16x16x32_bf16 v[68:71], v[196:199], v[144:147], v[68:71]
    ds_read_b128 v[116:119], v6 offset:45376
    v_mfma_f32_16x16x32_bf16 v[72:75], v[200:203], v[144:147], v[72:75]
    ds_read_b128 v[120:123], v7 offset:18496
    v_mfma_f32_16x16x32_bf16 v[76:79], v[204:207], v[144:147], v[76:79]
    v_mfma_f32_16x16x32_bf16 v[80:83], v[196:199], v[148:151], v[80:83]
    v_mfma_f32_16x16x32_bf16 v[84:87], v[200:203], v[148:151], v[84:87]
    v_mfma_f32_16x16x32_bf16 v[88:91], v[204:207], v[148:151], v[88:91]
    v_cvt_pk_bf16_f32 v20, v32, v33
    v_cvt_pk_bf16_f32 v21, v34, v35
    v_cvt_pk_bf16_f32 v22, v36, v37
    v_cvt_pk_bf16_f32 v23, v38, v39
    v_cvt_pk_bf16_f32 v24, v40, v41
    v_cvt_pk_bf16_f32 v25, v42, v43
    s_add_u32 s27, s31, 0
    buffer_store_dwordx4 v[20:23], v12, s[16:19], s27 offen
    buffer_store_dwordx2 v[24:25], v13, s[16:19], s27 offen
    s_waitcnt lgkmcnt(0)
    v_mfma_f32_16x16x32_bf16 v[68:71], v[208:211], v[116:119], v[68:71]
    ds_read_b128 v[144:147], v6 offset:45696
    v_mfma_f32_16x16x32_bf16 v[72:75], v[212:215], v[116:119], v[72:75]
    ds_read_b128 v[148:151], v7 offset:18816
    v_mfma_f32_16x16x32_bf16 v[76:79], v[216:219], v[116:119], v[76:79]
    v_mfma_f32_16x16x32_bf16 v[80:83], v[208:211], v[120:123], v[80:83]
    v_mfma_f32_16x16x32_bf16 v[84:87], v[212:215], v[120:123], v[84:87]
    v_mfma_f32_16x16x32_bf16 v[88:91], v[216:219], v[120:123], v[88:91]
    v_cvt_pk_bf16_f32 v26, v44, v45
    v_cvt_pk_bf16_f32 v27, v46, v47
    v_cvt_pk_bf16_f32 v28, v48, v49
    v_cvt_pk_bf16_f32 v29, v50, v51
    v_cvt_pk_bf16_f32 v30, v52, v53
    v_cvt_pk_bf16_f32 v31, v54, v55
    s_add_u32 s27, s31, 86016
    buffer_store_dwordx4 v[26:29], v12, s[16:19], s27 offen
    buffer_store_dwordx2 v[30:31], v13, s[16:19], s27 offen
    s_waitcnt lgkmcnt(0)
    v_mfma_f32_16x16x32_bf16 v[68:71], v[220:223], v[144:147], v[68:71]
    ds_read_b128 v[116:119], v6 offset:45760
    v_mfma_f32_16x16x32_bf16 v[72:75], v[224:227], v[144:147], v[72:75]
    ds_read_b128 v[120:123], v7 offset:18880
    v_mfma_f32_16x16x32_bf16 v[76:79], v[228:231], v[144:147], v[76:79]
    v_mfma_f32_16x16x32_bf16 v[80:83], v[220:223], v[148:151], v[80:83]
    v_mfma_f32_16x16x32_bf16 v[84:87], v[224:227], v[148:151], v[84:87]
    v_mfma_f32_16x16x32_bf16 v[88:91], v[228:231], v[148:151], v[88:91]
    v_cvt_pk_bf16_f32 v20, v56, v57
    v_cvt_pk_bf16_f32 v21, v58, v59
    v_cvt_pk_bf16_f32 v22, v60, v61
    v_cvt_pk_bf16_f32 v23, v62, v63
    v_cvt_pk_bf16_f32 v24, v64, v65
    v_cvt_pk_bf16_f32 v25, v66, v67
    s_add_u32 s27, s31, 172032
    buffer_store_dwordx4 v[20:23], v12, s[16:19], s27 offen
    buffer_store_dwordx2 v[24:25], v13, s[16:19], s27 offen
    s_waitcnt lgkmcnt(0)
    v_mfma_f32_16x16x32_bf16 v[68:71], v[232:235], v[116:119], v[68:71]
    ds_read_b128 v[144:147], v6 offset:45824
    v_mfma_f32_16x16x32_bf16 v[72:75], v[236:239], v[116:119], v[72:75]
    ds_read_b128 v[148:151], v7 offset:18944
    v_mfma_f32_16x16x32_bf16 v[76:79], v[240:243], v[116:119], v[76:79]
    v_mfma_f32_16x16x32_bf16 v[80:83], v[232:235], v[120:123], v[80:83]
    v_mfma_f32_16x16x32_bf16 v[84:87], v[236:239], v[120:123], v[84:87]
    v_mfma_f32_16x16x32_bf16 v[88:91], v[240:243], v[120:123], v[88:91]
    s_waitcnt lgkmcnt(0)
    v_mfma_f32_16x16x32_bf16 v[68:71], v[244:247], v[144:147], v[68:71]
    ds_read_b128 v[116:119], v7 offset:27328
    v_mfma_f32_16x16x32_bf16 v[72:75], v[248:251], v[144:147], v[72:75]
    ds_read_b128 v[120:123], v7 offset:36288
    v_mfma_f32_16x16x32_bf16 v[76:79], v[252:255], v[144:147], v[76:79]
    v_mfma_f32_16x16x32_bf16 v[80:83], v[244:247], v[148:151], v[80:83]
    v_mfma_f32_16x16x32_bf16 v[84:87], v[248:251], v[148:151], v[84:87]
    v_mfma_f32_16x16x32_bf16 v[88:91], v[252:255], v[148:151], v[88:91]
    s_waitcnt lgkmcnt(0)
    v_mfma_f32_16x16x32_bf16 v[92:95], v[184:187], v[116:119], v[92:95]
    ds_read_b128 v[144:147], v7 offset:27392
    v_mfma_f32_16x16x32_bf16 v[96:99], v[188:191], v[116:119], v[96:99]
    ds_read_b128 v[148:151], v7 offset:36352
    v_mfma_f32_16x16x32_bf16 v[100:103], v[192:195], v[116:119], v[100:103]
    v_mfma_f32_16x16x32_bf16 v[104:107], v[184:187], v[120:123], v[104:107]
    v_mfma_f32_16x16x32_bf16 v[108:111], v[188:191], v[120:123], v[108:111]
    v_mfma_f32_16x16x32_bf16 v[112:115], v[192:195], v[120:123], v[112:115]
    s_waitcnt lgkmcnt(0)
    v_mfma_f32_16x16x32_bf16 v[92:95], v[196:199], v[144:147], v[92:95]
    ds_read_b128 v[116:119], v7 offset:27456
    v_mfma_f32_16x16x32_bf16 v[96:99], v[200:203], v[144:147], v[96:99]
    ds_read_b128 v[120:123], v7 offset:36416
    v_mfma_f32_16x16x32_bf16 v[100:103], v[204:207], v[144:147], v[100:103]
    v_mfma_f32_16x16x32_bf16 v[104:107], v[196:199], v[148:151], v[104:107]
    v_mfma_f32_16x16x32_bf16 v[108:111], v[200:203], v[148:151], v[108:111]
    v_mfma_f32_16x16x32_bf16 v[112:115], v[204:207], v[148:151], v[112:115]
    v_cvt_pk_bf16_f32 v26, v68, v69
    v_cvt_pk_bf16_f32 v27, v70, v71
    v_cvt_pk_bf16_f32 v28, v72, v73
    v_cvt_pk_bf16_f32 v29, v74, v75
    v_cvt_pk_bf16_f32 v30, v76, v77
    v_cvt_pk_bf16_f32 v31, v78, v79
    s_add_u32 s27, s31, 258048
    buffer_store_dwordx4 v[26:29], v12, s[16:19], s27 offen
    buffer_store_dwordx2 v[30:31], v13, s[16:19], s27 offen
    s_waitcnt lgkmcnt(0)
    v_mfma_f32_16x16x32_bf16 v[92:95], v[208:211], v[116:119], v[92:95]
    ds_read_b128 v[144:147], v7 offset:27776
    v_mfma_f32_16x16x32_bf16 v[96:99], v[212:215], v[116:119], v[96:99]
    ds_read_b128 v[148:151], v7 offset:36736
    v_mfma_f32_16x16x32_bf16 v[100:103], v[216:219], v[116:119], v[100:103]
    v_mfma_f32_16x16x32_bf16 v[104:107], v[208:211], v[120:123], v[104:107]
    v_mfma_f32_16x16x32_bf16 v[108:111], v[212:215], v[120:123], v[108:111]
    v_mfma_f32_16x16x32_bf16 v[112:115], v[216:219], v[120:123], v[112:115]
    v_cvt_pk_bf16_f32 v20, v80, v81
    v_cvt_pk_bf16_f32 v21, v82, v83
    v_cvt_pk_bf16_f32 v22, v84, v85
    v_cvt_pk_bf16_f32 v23, v86, v87
    v_cvt_pk_bf16_f32 v24, v88, v89
    v_cvt_pk_bf16_f32 v25, v90, v91
    s_add_u32 s27, s31, 344064
    buffer_store_dwordx4 v[20:23], v12, s[16:19], s27 offen
    buffer_store_dwordx2 v[24:25], v13, s[16:19], s27 offen
    s_waitcnt lgkmcnt(0)
    v_mfma_f32_16x16x32_bf16 v[92:95], v[220:223], v[144:147], v[92:95]
    ds_read_b128 v[116:119], v7 offset:27840
    v_mfma_f32_16x16x32_bf16 v[96:99], v[224:227], v[144:147], v[96:99]
    ds_read_b128 v[120:123], v7 offset:36800
    v_mfma_f32_16x16x32_bf16 v[100:103], v[228:231], v[144:147], v[100:103]
    v_mfma_f32_16x16x32_bf16 v[104:107], v[220:223], v[148:151], v[104:107]
    v_mfma_f32_16x16x32_bf16 v[108:111], v[224:227], v[148:151], v[108:111]
    v_mfma_f32_16x16x32_bf16 v[112:115], v[228:231], v[148:151], v[112:115]
    s_waitcnt lgkmcnt(0)
    v_mfma_f32_16x16x32_bf16 v[92:95], v[232:235], v[116:119], v[92:95]
    ds_read_b128 v[144:147], v7 offset:27904
    v_mfma_f32_16x16x32_bf16 v[96:99], v[236:239], v[116:119], v[96:99]
    ds_read_b128 v[148:151], v7 offset:36864
    v_mfma_f32_16x16x32_bf16 v[100:103], v[240:243], v[116:119], v[100:103]
    v_mfma_f32_16x16x32_bf16 v[104:107], v[232:235], v[120:123], v[104:107]
    v_mfma_f32_16x16x32_bf16 v[108:111], v[236:239], v[120:123], v[108:111]
    v_mfma_f32_16x16x32_bf16 v[112:115], v[240:243], v[120:123], v[112:115]
    s_waitcnt lgkmcnt(0)
    v_mfma_f32_16x16x32_bf16 v[92:95], v[244:247], v[144:147], v[92:95]
    v_mfma_f32_16x16x32_bf16 v[96:99], v[248:251], v[144:147], v[96:99]
    v_mfma_f32_16x16x32_bf16 v[100:103], v[252:255], v[144:147], v[100:103]
    v_mfma_f32_16x16x32_bf16 v[104:107], v[244:247], v[148:151], v[104:107]
    v_mfma_f32_16x16x32_bf16 v[108:111], v[248:251], v[148:151], v[108:111]
    v_mfma_f32_16x16x32_bf16 v[112:115], v[252:255], v[148:151], v[112:115]
    s_nop 7
    s_nop 7
    v_cvt_pk_bf16_f32 v26, v92, v93
    v_cvt_pk_bf16_f32 v27, v94, v95
    v_cvt_pk_bf16_f32 v28, v96, v97
    v_cvt_pk_bf16_f32 v29, v98, v99
    v_cvt_pk_bf16_f32 v30, v100, v101
    v_cvt_pk_bf16_f32 v31, v102, v103
    s_add_u32 s27, s31, 430080
    buffer_store_dwordx4 v[26:29], v12, s[16:19], s27 offen
    buffer_store_dwordx2 v[30:31], v13, s[16:19], s27 offen
    v_cvt_pk_bf16_f32 v20, v104, v105
    v_cvt_pk_bf16_f32 v21, v106, v107
    v_cvt_pk_bf16_f32 v22, v108, v109
    v_cvt_pk_bf16_f32 v23, v110, v111
    v_cvt_pk_bf16_f32 v24, v112, v113
    v_cvt_pk_bf16_f32 v25, v114, v115
    s_add_u32 s27, s31, 516096
    buffer_store_dwordx4 v[20:23], v12, s[16:19], s27 offen
    buffer_store_dwordx2 v[24:25], v13, s[16:19], s27 offen
L_done:
    s_endpgm
.section .rodata,"a"
.p2align 6
.amdhsa_kernel standalone__dilated_atrous__vision_kernel
  .amdhsa_next_free_vgpr 512
  .amdhsa_next_free_sgpr 102
  .amdhsa_accum_offset 256
  .amdhsa_group_segment_fixed_size 0
  .amdhsa_kernarg_size 40
  .amdhsa_user_sgpr_count 2
  .amdhsa_user_sgpr_kernarg_segment_ptr 1
  .amdhsa_system_sgpr_workgroup_id_x 1
.end_amdhsa_kernel
```
